```python
import torch

def _softmax(x, axis=-1):
    return torch.softmax(x, dim=axis)
def _gelu(x):
    return torch.nn.functional.gelu(x, approximate="tanh")
def _silu(x):
    return torch.nn.functional.silu(x)
def _sigmoid(x):
    return torch.sigmoid(x)
def _layernorm(x, axis=-1, eps=1e-5):
    m = x.mean(dim=axis, keepdim=True)
    v = x.var(dim=axis, keepdim=True, unbiased=False)
    return (x - m) / torch.sqrt(v + eps)
def _scatter_add(tgt, idx, src, axis=0):
    return tgt.clone().index_add_(axis, idx, src)
def _segment_sum(src, seg, n):
    out = torch.zeros((n,) + src.shape[1:], dtype=src.dtype)
    return out.index_add_(0, seg, src)
def _pad(x, pw):
    flat = tuple(v for pair in reversed(pw) for v in pair)
    return torch.nn.functional.pad(x, flat)

kernel_name = 'standalone__mixer_s_mlp__prompt'

def setup_inputs():

    _w = (lambda a: (lambda t: t.to(torch.bfloat16) if t.is_floating_point() else t)(torch.as_tensor(a)))
    B, S, D, F = 1, 2048, 1024, 3584
    return {
        "x":  _w((lambda *s: torch.randn(*s, dtype=torch.bfloat16) * 0.4)(B, S, D)),
        "w1": _w((lambda *s: torch.randn(*s, dtype=torch.bfloat16) * 3.2)(D, D) * (D ** -0.5)),
        "w2": _w((lambda *s: torch.randn(*s, dtype=torch.bfloat16) * 3.2)(D, D) * (D ** -0.5)),
        "w3": _w((lambda *s: torch.randn(*s, dtype=torch.bfloat16) * 3.2)(D, F) * (D ** -0.5)),
        "w4": _w((lambda *s: torch.randn(*s, dtype=torch.bfloat16) * 0.8)(F, D) * (F ** -0.5)),
    }

def reference(x, w1, w2, w3, w4):
    B, S, D = x.shape
    h = _gelu(_layernorm(x, axis=-1) @ w1)
    c = D // 4
    g0 = _pad(h[:, :, 0*c:1*c], ((0, 0), (1, 0), (0, 0)))[:, :S, :]
    g1 = _pad(h[:, :, 1*c:2*c], ((0, 0), (0, 1), (0, 0)))[:, 1:, :]
    g2 = _pad(h[:, :, 2*c:3*c], ((0, 0), (2, 0), (0, 0)))[:, :S, :]
    g3 = _pad(h[:, :, 3*c:   ], ((0, 0), (0, 2), (0, 0)))[:, 2:, :]
    hs = torch.concatenate([g0, g1, g2, g3], axis=-1) @ w2
    x1 = x + hs
    h2 = _gelu(_layernorm(x1, axis=-1) @ w3) @ w4
    return x1 + h2
```

```asm
; @launch grid=(256,1,1) block=(512,1,1) lds=163840
.amdgcn_target "amdgcn-amd-amdhsa--gfx950"
.text
.globl standalone__mixer_s_mlp__prompt_kernel
.p2align 8
.type standalone__mixer_s_mlp__prompt_kernel,@function
standalone__mixer_s_mlp__prompt_kernel:
k1_kernel:
    s_cmp_ge_u32 s2, 256
    s_cbranch_scc1 k1_kernel_done
    s_load_dwordx16 s[56:71], s[0:1], 0
    s_and_b32 s53, s2, 7
    s_lshr_b32 s54, s2, 3
    s_lshr_b32 s45, s53, 1
    s_and_b32 s45, s45, 3
    s_lshl_b32 s45, s45, 2
    s_lshr_b32 s46, s54, 3
    s_and_b32 s46, s46, 3
    s_add_u32 s48, s45, s46
    s_lshr_b32 s45, s53, 0
    s_and_b32 s45, s45, 1
    s_lshl_b32 s45, s45, 3
    s_lshr_b32 s46, s54, 0
    s_and_b32 s46, s46, 7
    s_add_u32 s49, s45, s46
    s_lshl_b32 s33, s48, 7
    s_mul_i32 s34, s49, 64
    v_lshrrev_b32 v1, 6, v0
    v_and_b32 v2, 63, v0
    s_nop 0
    v_readfirstlane_b32 s32, v1
    s_mov_b32 s50, 0xc0135761
    s_mov_b32 s51, 0xbdd2d3e8
    s_mov_b32 s52, 0xffff0000
    s_waitcnt lgkmcnt(0)
    s_mov_b32 s8, s56
    s_mov_b32 s9, s57
    s_mov_b32 s10, 0x400000
    s_mov_b32 s11, 0x20000
    s_mov_b32 s12, s58
    s_mov_b32 s13, s59
    s_mov_b32 s14, 0x200000
    s_mov_b32 s15, 0x20000
    s_cmp_lt_u32 s32, 4
    s_cbranch_scc1 k1_kernel_cons
k1_kernel_prod:
    s_sub_u32 s35, s32, 4
    v_lshrrev_b32 v3, 3, v2
    v_and_b32 v4, 7, v2
    v_lshrrev_b32 v5, 4, v2
    s_lshl_b32 s44, s35, 5
    s_add_u32 s44, s44, s33
    s_mov_b32 s45, 2048
    v_add_u32 v6, s44, v3
    v_mul_lo_u32 v6, v6, s45
    v_xor_b32 v7, v4, v5
    v_lshl_add_u32 v8, v7, 4, v6
    v_xor_b32 v7, 4, v7
    v_lshl_add_u32 v9, v7, 4, v6
    v_add_u32 v9, 16384, v9
    v_add_u32 v10, 32768, v8
    v_add_u32 v11, 32768, v9
    s_lshl_b32 s46, s34, 1
    s_mov_b32 s45, 2048
    s_lshl_b32 s44, s35, 4
    v_add_u32 v6, s44, v3
    v_mul_lo_u32 v6, v6, s45
    v_add_u32 v6, s46, v6
    v_and_b32 v7, 1, v5
    v_lshlrev_b32 v7, 1, v7
    v_xor_b32 v7, v4, v7
    v_lshl_add_u32 v12, v7, 4, v6
    v_xor_b32 v7, 4, v7
    v_lshl_add_u32 v13, v7, 4, v6
    v_add_u32 v13, 16384, v13
    s_lshl_b32 s42, s35, 12
    s_mul_i32 s43, s35, 2048
    s_add_u32 s43, s43, 16384
    s_mul_i32 s44, s49, 1
    s_mul_i32 s45, s48, 1
    s_add_u32 s44, s44, s45
    s_and_b32 s44, s44, 15
    s_lshl_b32 s4, s44, 7
    s_mul_i32 s5, s44, 131072
    s_mov_b32 s38, s4
    s_mov_b32 s39, s5
    s_add_u32 s4, s4, 128
    s_add_u32 s5, s5, 131072
    s_cmp_eq_u32 s4, 2048
    s_cselect_b32 s4, 0, s4
    s_cselect_b32 s5, 0, s5
    s_add_u32 m0, s42, 0x0
    s_nop 0
    buffer_load_dwordx4 v8, s[8:11], s38 offen lds
    s_add_u32 m0, s42, 0x400
    s_nop 0
    buffer_load_dwordx4 v9, s[8:11], s38 offen lds
    s_add_u32 m0, s42, 0x800
    s_nop 0
    buffer_load_dwordx4 v10, s[8:11], s38 offen lds
    s_add_u32 m0, s42, 0xc00
    s_nop 0
    buffer_load_dwordx4 v11, s[8:11], s38 offen lds
    s_add_u32 m0, s43, 0x0
    s_nop 0
    buffer_load_dwordx4 v12, s[12:15], s39 offen lds
    s_add_u32 m0, s43, 0x400
    s_nop 0
    buffer_load_dwordx4 v13, s[12:15], s39 offen lds
    s_mov_b32 s38, s4
    s_mov_b32 s39, s5
    s_add_u32 s4, s4, 128
    s_add_u32 s5, s5, 131072
    s_cmp_eq_u32 s4, 2048
    s_cselect_b32 s4, 0, s4
    s_cselect_b32 s5, 0, s5
    s_add_u32 m0, s42, 0x6000
    s_nop 0
    buffer_load_dwordx4 v8, s[8:11], s38 offen lds
    s_add_u32 m0, s42, 0x6400
    s_nop 0
    buffer_load_dwordx4 v9, s[8:11], s38 offen lds
    s_add_u32 m0, s42, 0x6800
    s_nop 0
    buffer_load_dwordx4 v10, s[8:11], s38 offen lds
    s_add_u32 m0, s42, 0x6c00
    s_nop 0
    buffer_load_dwordx4 v11, s[8:11], s38 offen lds
    s_add_u32 m0, s43, 0x6000
    s_nop 0
    buffer_load_dwordx4 v12, s[12:15], s39 offen lds
    s_add_u32 m0, s43, 0x6400
    s_nop 0
    buffer_load_dwordx4 v13, s[12:15], s39 offen lds
    s_mov_b32 s20, s70
    s_mov_b32 s21, s71
    s_mov_b32 s22, 0x440000
    s_mov_b32 s23, 0x20000
    s_add_u32 s24, s70, 0x1a80000
    s_addc_u32 s25, s71, 0
    s_mov_b32 s26, 0x40000
    s_mov_b32 s27, 0x20000
    s_add_u32 s28, s70, 0x1ac0000
    s_addc_u32 s29, s71, 0
    s_mov_b32 s30, 0x10000
    s_mov_b32 s31, 0x20000
    s_waitcnt vmcnt(6)
    s_barrier
    s_mov_b32 s38, s4
    s_mov_b32 s39, s5
    s_add_u32 s4, s4, 128
    s_add_u32 s5, s5, 131072
    s_cmp_eq_u32 s4, 2048
    s_cselect_b32 s4, 0, s4
    s_cselect_b32 s5, 0, s5
    s_add_u32 m0, s42, 0xc000
    s_nop 0
    buffer_load_dwordx4 v8, s[8:11], s38 offen lds
    s_add_u32 m0, s42, 0xc400
    s_nop 0
    buffer_load_dwordx4 v9, s[8:11], s38 offen lds
    s_add_u32 m0, s42, 0xc800
    s_nop 0
    buffer_load_dwordx4 v10, s[8:11], s38 offen lds
    s_add_u32 m0, s42, 0xcc00
    s_nop 0
    buffer_load_dwordx4 v11, s[8:11], s38 offen lds
    s_add_u32 m0, s43, 0xc000
    s_nop 0
    buffer_load_dwordx4 v12, s[12:15], s39 offen lds
    s_add_u32 m0, s43, 0xc400
    s_nop 0
    buffer_load_dwordx4 v13, s[12:15], s39 offen lds
    s_mov_b32 s38, s4
    s_mov_b32 s39, s5
    s_add_u32 s4, s4, 128
    s_add_u32 s5, s5, 131072
    s_cmp_eq_u32 s4, 2048
    s_cselect_b32 s4, 0, s4
    s_cselect_b32 s5, 0, s5
    s_add_u32 m0, s42, 0x12000
    s_nop 0
    buffer_load_dwordx4 v8, s[8:11], s38 offen lds
    s_add_u32 m0, s42, 0x12400
    s_nop 0
    buffer_load_dwordx4 v9, s[8:11], s38 offen lds
    s_add_u32 m0, s42, 0x12800
    s_nop 0
    buffer_load_dwordx4 v10, s[8:11], s38 offen lds
    s_add_u32 m0, s42, 0x12c00
    s_nop 0
    buffer_load_dwordx4 v11, s[8:11], s38 offen lds
    s_add_u32 m0, s43, 0x12000
    s_nop 0
    buffer_load_dwordx4 v12, s[12:15], s39 offen lds
    s_add_u32 m0, s43, 0x12400
    s_nop 0
    buffer_load_dwordx4 v13, s[12:15], s39 offen lds
    s_waitcnt vmcnt(12)
    s_barrier
    s_mov_b32 s38, s4
    s_mov_b32 s39, s5
    s_add_u32 s4, s4, 128
    s_add_u32 s5, s5, 131072
    s_cmp_eq_u32 s4, 2048
    s_cselect_b32 s4, 0, s4
    s_cselect_b32 s5, 0, s5
    s_add_u32 m0, s42, 0x18000
    s_nop 0
    buffer_load_dwordx4 v8, s[8:11], s38 offen lds
    s_add_u32 m0, s42, 0x18400
    s_nop 0
    buffer_load_dwordx4 v9, s[8:11], s38 offen lds
    s_add_u32 m0, s42, 0x18800
    s_nop 0
    buffer_load_dwordx4 v10, s[8:11], s38 offen lds
    s_add_u32 m0, s42, 0x18c00
    s_nop 0
    buffer_load_dwordx4 v11, s[8:11], s38 offen lds
    s_add_u32 m0, s43, 0x18000
    s_nop 0
    buffer_load_dwordx4 v12, s[12:15], s39 offen lds
    s_add_u32 m0, s43, 0x18400
    s_nop 0
    buffer_load_dwordx4 v13, s[12:15], s39 offen lds
    s_mov_b32 s38, s4
    s_mov_b32 s39, s5
    s_add_u32 s4, s4, 128
    s_add_u32 s5, s5, 131072
    s_cmp_eq_u32 s4, 2048
    s_cselect_b32 s4, 0, s4
    s_cselect_b32 s5, 0, s5
    s_add_u32 m0, s42, 0x1e000
    s_nop 0
    buffer_load_dwordx4 v8, s[8:11], s38 offen lds
    s_add_u32 m0, s42, 0x1e400
    s_nop 0
    buffer_load_dwordx4 v9, s[8:11], s38 offen lds
    s_add_u32 m0, s42, 0x1e800
    s_nop 0
    buffer_load_dwordx4 v10, s[8:11], s38 offen lds
    s_add_u32 m0, s42, 0x1ec00
    s_nop 0
    buffer_load_dwordx4 v11, s[8:11], s38 offen lds
    s_add_u32 m0, s43, 0x1e000
    s_nop 0
    buffer_load_dwordx4 v12, s[12:15], s39 offen lds
    s_add_u32 m0, s43, 0x1e400
    s_nop 0
    buffer_load_dwordx4 v13, s[12:15], s39 offen lds
    s_waitcnt vmcnt(18)
    s_barrier
    s_mov_b32 s38, s4
    s_mov_b32 s39, s5
    s_add_u32 s4, s4, 128
    s_add_u32 s5, s5, 131072
    s_cmp_eq_u32 s4, 2048
    s_cselect_b32 s4, 0, s4
    s_cselect_b32 s5, 0, s5
    s_add_u32 m0, s42, 0x0
    s_nop 0
    buffer_load_dwordx4 v8, s[8:11], s38 offen lds
    s_add_u32 m0, s42, 0x400
    s_nop 0
    buffer_load_dwordx4 v9, s[8:11], s38 offen lds
    s_add_u32 m0, s42, 0x800
    s_nop 0
    buffer_load_dwordx4 v10, s[8:11], s38 offen lds
    s_add_u32 m0, s42, 0xc00
    s_nop 0
    buffer_load_dwordx4 v11, s[8:11], s38 offen lds
    s_add_u32 m0, s43, 0x0
    s_nop 0
    buffer_load_dwordx4 v12, s[12:15], s39 offen lds
    s_add_u32 m0, s43, 0x400
    s_nop 0
    buffer_load_dwordx4 v13, s[12:15], s39 offen lds
    s_mov_b32 s38, s4
    s_mov_b32 s39, s5
    s_add_u32 s4, s4, 128
    s_add_u32 s5, s5, 131072
    s_cmp_eq_u32 s4, 2048
    s_cselect_b32 s4, 0, s4
    s_cselect_b32 s5, 0, s5
    s_add_u32 m0, s42, 0x6000
    s_nop 0
    buffer_load_dwordx4 v8, s[8:11], s38 offen lds
    s_add_u32 m0, s42, 0x6400
    s_nop 0
    buffer_load_dwordx4 v9, s[8:11], s38 offen lds
    s_add_u32 m0, s42, 0x6800
    s_nop 0
    buffer_load_dwordx4 v10, s[8:11], s38 offen lds
    s_add_u32 m0, s42, 0x6c00
    s_nop 0
    buffer_load_dwordx4 v11, s[8:11], s38 offen lds
    s_add_u32 m0, s43, 0x6000
    s_nop 0
    buffer_load_dwordx4 v12, s[12:15], s39 offen lds
    s_add_u32 m0, s43, 0x6400
    s_nop 0
    buffer_load_dwordx4 v13, s[12:15], s39 offen lds
    s_waitcnt vmcnt(24)
    s_barrier
    s_mov_b32 s38, s4
    s_mov_b32 s39, s5
    s_add_u32 s4, s4, 128
    s_add_u32 s5, s5, 131072
    s_cmp_eq_u32 s4, 2048
    s_cselect_b32 s4, 0, s4
    s_cselect_b32 s5, 0, s5
    s_add_u32 m0, s42, 0xc000
    s_nop 0
    buffer_load_dwordx4 v8, s[8:11], s38 offen lds
    s_add_u32 m0, s42, 0xc400
    s_nop 0
    buffer_load_dwordx4 v9, s[8:11], s38 offen lds
    s_add_u32 m0, s42, 0xc800
    s_nop 0
    buffer_load_dwordx4 v10, s[8:11], s38 offen lds
    s_add_u32 m0, s42, 0xcc00
    s_nop 0
    buffer_load_dwordx4 v11, s[8:11], s38 offen lds
    s_add_u32 m0, s43, 0xc000
    s_nop 0
    buffer_load_dwordx4 v12, s[12:15], s39 offen lds
    s_add_u32 m0, s43, 0xc400
    s_nop 0
    buffer_load_dwordx4 v13, s[12:15], s39 offen lds
    s_mov_b32 s16, s68
    s_mov_b32 s17, s69
    s_mov_b32 s18, 0x100
    s_mov_b32 s19, 0x20000
    v_mov_b32 v30, 0
    buffer_load_dwordx2 v[24:25], v30, s[16:19], 0 offen sc1
    s_waitcnt vmcnt(25)
    s_barrier
    s_mov_b32 s38, s4
    s_mov_b32 s39, s5
    s_add_u32 s4, s4, 128
    s_add_u32 s5, s5, 131072
    s_cmp_eq_u32 s4, 2048
    s_cselect_b32 s4, 0, s4
    s_cselect_b32 s5, 0, s5
    s_add_u32 m0, s42, 0x12000
    s_nop 0
    buffer_load_dwordx4 v8, s[8:11], s38 offen lds
    s_add_u32 m0, s42, 0x12400
    s_nop 0
    buffer_load_dwordx4 v9, s[8:11], s38 offen lds
    s_add_u32 m0, s42, 0x12800
    s_nop 0
    buffer_load_dwordx4 v10, s[8:11], s38 offen lds
    s_add_u32 m0, s42, 0x12c00
    s_nop 0
    buffer_load_dwordx4 v11, s[8:11], s38 offen lds
    s_add_u32 m0, s43, 0x12000
    s_nop 0
    buffer_load_dwordx4 v12, s[12:15], s39 offen lds
    s_add_u32 m0, s43, 0x12400
    s_nop 0
    buffer_load_dwordx4 v13, s[12:15], s39 offen lds
    s_waitcnt vmcnt(25)
    s_barrier
    s_mov_b32 s38, s4
    s_mov_b32 s39, s5
    s_add_u32 s4, s4, 128
    s_add_u32 s5, s5, 131072
    s_cmp_eq_u32 s4, 2048
    s_cselect_b32 s4, 0, s4
    s_cselect_b32 s5, 0, s5
    s_add_u32 m0, s42, 0x18000
    s_nop 0
    buffer_load_dwordx4 v8, s[8:11], s38 offen lds
    s_add_u32 m0, s42, 0x18400
    s_nop 0
    buffer_load_dwordx4 v9, s[8:11], s38 offen lds
    s_add_u32 m0, s42, 0x18800
    s_nop 0
    buffer_load_dwordx4 v10, s[8:11], s38 offen lds
    s_add_u32 m0, s42, 0x18c00
    s_nop 0
    buffer_load_dwordx4 v11, s[8:11], s38 offen lds
    s_add_u32 m0, s43, 0x18000
    s_nop 0
    buffer_load_dwordx4 v12, s[12:15], s39 offen lds
    s_add_u32 m0, s43, 0x18400
    s_nop 0
    buffer_load_dwordx4 v13, s[12:15], s39 offen lds
    s_waitcnt vmcnt(25)
    s_barrier
    s_mov_b32 s38, s4
    s_mov_b32 s39, s5
    s_add_u32 s4, s4, 128
    s_add_u32 s5, s5, 131072
    s_cmp_eq_u32 s4, 2048
    s_cselect_b32 s4, 0, s4
    s_cselect_b32 s5, 0, s5
    s_add_u32 m0, s42, 0x1e000
    s_nop 0
    buffer_load_dwordx4 v8, s[8:11], s38 offen lds
    s_add_u32 m0, s42, 0x1e400
    s_nop 0
    buffer_load_dwordx4 v9, s[8:11], s38 offen lds
    s_add_u32 m0, s42, 0x1e800
    s_nop 0
    buffer_load_dwordx4 v10, s[8:11], s38 offen lds
    s_add_u32 m0, s42, 0x1ec00
    s_nop 0
    buffer_load_dwordx4 v11, s[8:11], s38 offen lds
    s_add_u32 m0, s43, 0x1e000
    s_nop 0
    buffer_load_dwordx4 v12, s[12:15], s39 offen lds
    s_add_u32 m0, s43, 0x1e400
    s_nop 0
    buffer_load_dwordx4 v13, s[12:15], s39 offen lds
    s_waitcnt vmcnt(25)
    s_barrier
    s_mov_b32 s38, s4
    s_mov_b32 s39, s5
    s_add_u32 s4, s4, 128
    s_add_u32 s5, s5, 131072
    s_cmp_eq_u32 s4, 2048
    s_cselect_b32 s4, 0, s4
    s_cselect_b32 s5, 0, s5
    s_add_u32 m0, s42, 0x0
    s_nop 0
    buffer_load_dwordx4 v8, s[8:11], s38 offen lds
    s_add_u32 m0, s42, 0x400
    s_nop 0
    buffer_load_dwordx4 v9, s[8:11], s38 offen lds
    s_add_u32 m0, s42, 0x800
    s_nop 0
    buffer_load_dwordx4 v10, s[8:11], s38 offen lds
    s_add_u32 m0, s42, 0xc00
    s_nop 0
    buffer_load_dwordx4 v11, s[8:11], s38 offen lds
    s_add_u32 m0, s43, 0x0
    s_nop 0
    buffer_load_dwordx4 v12, s[12:15], s39 offen lds
    s_add_u32 m0, s43, 0x400
    s_nop 0
    buffer_load_dwordx4 v13, s[12:15], s39 offen lds
    s_waitcnt vmcnt(25)
    s_barrier
    s_mov_b32 s38, s4
    s_mov_b32 s39, s5
    s_add_u32 s4, s4, 128
    s_add_u32 s5, s5, 131072
    s_cmp_eq_u32 s4, 2048
    s_cselect_b32 s4, 0, s4
    s_cselect_b32 s5, 0, s5
    s_add_u32 m0, s42, 0x6000
    s_nop 0
    buffer_load_dwordx4 v8, s[8:11], s38 offen lds
    s_add_u32 m0, s42, 0x6400
    s_nop 0
    buffer_load_dwordx4 v9, s[8:11], s38 offen lds
    s_add_u32 m0, s42, 0x6800
    s_nop 0
    buffer_load_dwordx4 v10, s[8:11], s38 offen lds
    s_add_u32 m0, s42, 0x6c00
    s_nop 0
    buffer_load_dwordx4 v11, s[8:11], s38 offen lds
    s_add_u32 m0, s43, 0x6000
    s_nop 0
    buffer_load_dwordx4 v12, s[12:15], s39 offen lds
    s_add_u32 m0, s43, 0x6400
    s_nop 0
    buffer_load_dwordx4 v13, s[12:15], s39 offen lds
    s_waitcnt vmcnt(24)
    s_barrier
    s_mov_b32 s38, s4
    s_mov_b32 s39, s5
    s_add_u32 s4, s4, 128
    s_add_u32 s5, s5, 131072
    s_cmp_eq_u32 s4, 2048
    s_cselect_b32 s4, 0, s4
    s_cselect_b32 s5, 0, s5
    s_add_u32 m0, s42, 0xc000
    s_nop 0
    buffer_load_dwordx4 v8, s[8:11], s38 offen lds
    s_add_u32 m0, s42, 0xc400
    s_nop 0
    buffer_load_dwordx4 v9, s[8:11], s38 offen lds
    s_add_u32 m0, s42, 0xc800
    s_nop 0
    buffer_load_dwordx4 v10, s[8:11], s38 offen lds
    s_add_u32 m0, s42, 0xcc00
    s_nop 0
    buffer_load_dwordx4 v11, s[8:11], s38 offen lds
    s_add_u32 m0, s43, 0xc000
    s_nop 0
    buffer_load_dwordx4 v12, s[12:15], s39 offen lds
    s_add_u32 m0, s43, 0xc400
    s_nop 0
    buffer_load_dwordx4 v13, s[12:15], s39 offen lds
    s_waitcnt vmcnt(36)
k1_kernel_nchk:
    v_readfirstlane_b32 s6, v24
    v_readfirstlane_b32 s7, v25
    s_nop 3
    s_bitcmp1_b32 s6, 0
    s_cbranch_scc1 k1_kernel_nok
    buffer_load_dwordx2 v[24:25], v30, s[16:19], 0 offen sc1
    s_waitcnt vmcnt(0)
    s_branch k1_kernel_nchk
k1_kernel_nok:
    s_waitcnt vmcnt(24)
    s_barrier
    s_mov_b32 s38, s4
    s_mov_b32 s39, s5
    s_add_u32 s4, s4, 128
    s_add_u32 s5, s5, 131072
    s_cmp_eq_u32 s4, 2048
    s_cselect_b32 s4, 0, s4
    s_cselect_b32 s5, 0, s5
    s_add_u32 m0, s42, 0x12000
    s_nop 0
    buffer_load_dwordx4 v8, s[8:11], s38 offen lds
    s_add_u32 m0, s42, 0x12400
    s_nop 0
    buffer_load_dwordx4 v9, s[8:11], s38 offen lds
    s_add_u32 m0, s42, 0x12800
    s_nop 0
    buffer_load_dwordx4 v10, s[8:11], s38 offen lds
    s_add_u32 m0, s42, 0x12c00
    s_nop 0
    buffer_load_dwordx4 v11, s[8:11], s38 offen lds
    s_add_u32 m0, s43, 0x12000
    s_nop 0
    buffer_load_dwordx4 v12, s[12:15], s39 offen lds
    s_add_u32 m0, s43, 0x12400
    s_nop 0
    buffer_load_dwordx4 v13, s[12:15], s39 offen lds
    s_lshl_b32 s44, s32, 7
    s_add_u32 s44, s44, 0
    v_add_u32 v5, s44, v2
    v_lshrrev_b32 v3, 3, v5
    v_and_b32 v4, 7, v5
    v_add_u32 v3, s33, v3
    v_lshlrev_b32 v4, 4, v4
    s_lshl_b32 s45, s34, 1
    v_add_u32 v4, s45, v4
    v_mul_u32_u24 v5, 2176, v3
    v_add_u32 v248, v5, v4
    s_lshl_b32 s44, s32, 7
    s_add_u32 s44, s44, 64
    v_add_u32 v5, s44, v2
    v_lshrrev_b32 v3, 3, v5
    v_and_b32 v4, 7, v5
    v_add_u32 v3, s33, v3
    v_lshlrev_b32 v4, 4, v4
    s_lshl_b32 s45, s34, 1
    v_add_u32 v4, s45, v4
    v_mul_u32_u24 v5, 2176, v3
    v_add_u32 v249, v5, v4
    s_add_u32 s72, s70, 0x1b10000
    s_addc_u32 s73, s71, 0
    s_mov_b32 s74, 0x8000
    s_mov_b32 s75, 0x20000
    s_mov_b32 s16, s68
    s_mov_b32 s17, s69
    s_mov_b32 s18, 0x100
    s_mov_b32 s19, 0x20000
    v_and_b32 v31, 15, v2
    s_lshl_b32 s44, s48, 4
    v_add_u32 v29, s44, v31
    v_lshlrev_b32 v31, 4, v31
    v_add_u32 v31, s49, v31
    v_and_b32 v30, 16, v2
    v_cmp_eq_u32 vcc, 0, v30
    v_mov_b32 v30, 0
    s_nop 0
    v_cndmask_b32 v31, v31, v29, vcc
    v_lshlrev_b32 v31, 7, v31
    buffer_load_dwordx2 v[24:25], v30, s[16:19], 0 offen sc1
    buffer_load_dwordx2 v[26:27], v31, s[72:75], 0 offen sc1
    s_waitcnt vmcnt(26)
    s_barrier
    s_waitcnt vmcnt(20)
    s_barrier
    s_waitcnt vmcnt(0)
k1_kernel_fchk:
    v_xor_b32 v28, v24, v26
    v_xor_b32 v29, v25, v27
    v_or_b32 v28, v28, v29
    v_and_b32 v29, 1, v24
    v_xor_b32 v29, 1, v29
    v_or_b32 v28, v28, v29
    v_cmp_ne_u32 vcc, 0, v28
    s_nop 4
    s_cmp_eq_u64 vcc, 0
    s_cbranch_scc1 k1_kernel_fok
    buffer_load_dwordx2 v[24:25], v30, s[16:19], 0 offen sc1
    buffer_load_dwordx2 v[26:27], v31, s[72:75], 0 offen sc1
    s_waitcnt vmcnt(0)
    s_branch k1_kernel_fchk
k1_kernel_fok:
    s_cmp_gt_u32 s35, 1
    s_cbranch_scc1 k1_kernel_gcs
    v_subrev_u32 v28, 256, v0
    v_add_u32 v26, s33, v28
    v_lshlrev_b32 v26, 3, v26
    s_mov_b32 s44, 0
    buffer_load_dwordx2 v[32:33], v26, s[24:27], s44 offen sc1
    s_mov_b32 s44, 16384
    buffer_load_dwordx2 v[34:35], v26, s[24:27], s44 offen sc1
    s_mov_b32 s44, 32768
    buffer_load_dwordx2 v[36:37], v26, s[24:27], s44 offen sc1
    s_mov_b32 s44, 49152
    buffer_load_dwordx2 v[38:39], v26, s[24:27], s44 offen sc1
    s_mov_b32 s44, 65536
    buffer_load_dwordx2 v[40:41], v26, s[24:27], s44 offen sc1
    s_mov_b32 s44, 81920
    buffer_load_dwordx2 v[42:43], v26, s[24:27], s44 offen sc1
    s_mov_b32 s44, 98304
    buffer_load_dwordx2 v[44:45], v26, s[24:27], s44 offen sc1
    s_mov_b32 s44, 114688
    buffer_load_dwordx2 v[46:47], v26, s[24:27], s44 offen sc1
    s_mov_b32 s44, 131072
    buffer_load_dwordx2 v[48:49], v26, s[24:27], s44 offen sc1
    s_mov_b32 s44, 147456
    buffer_load_dwordx2 v[50:51], v26, s[24:27], s44 offen sc1
    s_mov_b32 s44, 163840
    buffer_load_dwordx2 v[52:53], v26, s[24:27], s44 offen sc1
    s_mov_b32 s44, 180224
    buffer_load_dwordx2 v[54:55], v26, s[24:27], s44 offen sc1
    s_mov_b32 s44, 196608
    buffer_load_dwordx2 v[56:57], v26, s[24:27], s44 offen sc1
    s_mov_b32 s44, 212992
    buffer_load_dwordx2 v[58:59], v26, s[24:27], s44 offen sc1
    s_mov_b32 s44, 229376
    buffer_load_dwordx2 v[60:61], v26, s[24:27], s44 offen sc1
    s_mov_b32 s44, 245760
    buffer_load_dwordx2 v[62:63], v26, s[24:27], s44 offen sc1
    s_branch k1_kernel_gdn
k1_kernel_gcs:
    v_add_u32 v26, s34, v2
    v_lshlrev_b32 v26, 2, v26
    s_mov_b32 s44, 0
    buffer_load_dword v32, v26, s[28:31], s44 offen sc1
    s_mov_b32 s44, 4096
    buffer_load_dword v33, v26, s[28:31], s44 offen sc1
    s_mov_b32 s44, 8192
    buffer_load_dword v34, v26, s[28:31], s44 offen sc1
    s_mov_b32 s44, 12288
    buffer_load_dword v35, v26, s[28:31], s44 offen sc1
    s_mov_b32 s44, 16384
    buffer_load_dword v36, v26, s[28:31], s44 offen sc1
    s_mov_b32 s44, 20480
    buffer_load_dword v37, v26, s[28:31], s44 offen sc1
    s_mov_b32 s44, 24576
    buffer_load_dword v38, v26, s[28:31], s44 offen sc1
    s_mov_b32 s44, 28672
    buffer_load_dword v39, v26, s[28:31], s44 offen sc1
    s_mov_b32 s44, 32768
    buffer_load_dword v40, v26, s[28:31], s44 offen sc1
    s_mov_b32 s44, 36864
    buffer_load_dword v41, v26, s[28:31], s44 offen sc1
    s_mov_b32 s44, 40960
    buffer_load_dword v42, v26, s[28:31], s44 offen sc1
    s_mov_b32 s44, 45056
    buffer_load_dword v43, v26, s[28:31], s44 offen sc1
    s_mov_b32 s44, 49152
    buffer_load_dword v44, v26, s[28:31], s44 offen sc1
    s_mov_b32 s44, 53248
    buffer_load_dword v45, v26, s[28:31], s44 offen sc1
    s_mov_b32 s44, 57344
    buffer_load_dword v46, v26, s[28:31], s44 offen sc1
    s_mov_b32 s44, 61440
    buffer_load_dword v47, v26, s[28:31], s44 offen sc1
k1_kernel_gdn:
    s_waitcnt vmcnt(30)
    s_barrier
    s_waitcnt vmcnt(24)
    s_barrier
    s_waitcnt vmcnt(18)
    s_barrier
    s_waitcnt vmcnt(0)
    s_cmp_gt_u32 s35, 1
    s_cbranch_scc1 k1_kernel_pcs2
    v_add_f32 v32, v32, v34
    v_add_f32 v33, v33, v35
    v_add_f32 v32, v32, v36
    v_add_f32 v33, v33, v37
    v_add_f32 v32, v32, v38
    v_add_f32 v33, v33, v39
    v_add_f32 v32, v32, v40
    v_add_f32 v33, v33, v41
    v_add_f32 v32, v32, v42
    v_add_f32 v33, v33, v43
    v_add_f32 v32, v32, v44
    v_add_f32 v33, v33, v45
    v_add_f32 v32, v32, v46
    v_add_f32 v33, v33, v47
    v_add_f32 v32, v32, v48
    v_add_f32 v33, v33, v49
    v_add_f32 v32, v32, v50
    v_add_f32 v33, v33, v51
    v_add_f32 v32, v32, v52
    v_add_f32 v33, v33, v53
    v_add_f32 v32, v32, v54
    v_add_f32 v33, v33, v55
    v_add_f32 v32, v32, v56
    v_add_f32 v33, v33, v57
    v_add_f32 v32, v32, v58
    v_add_f32 v33, v33, v59
    v_add_f32 v32, v32, v60
    v_add_f32 v33, v33, v61
    v_add_f32 v32, v32, v62
    v_add_f32 v33, v33, v63
    v_mul_f32 v32, 0x3a800000, v32
    v_mul_f32 v33, 0x3a800000, v33
    v_fma_f32 v33, -v32, v32, v33
    v_max_f32 v33, 0, v33
    v_cvt_pk_bf16_f32 v32, v32, v33
    v_lshlrev_b32 v36, 16, v32
    v_and_b32 v33, s52, v32
    v_xor_b32 v36, 0x80000000, v36
    v_add_f32 v33, 0x3727c5ac, v33
    v_cvt_pk_bf16_f32 v33, v33, v33
    v_and_b32 v33, s52, v33
    v_sqrt_f32 v33, v33
    s_nop 0
    v_cvt_pk_bf16_f32 v33, v33, v33
    v_and_b32 v39, s52, v33
    v_rcp_f32 v33, v39
    s_nop 0
    v_mul_f32 v37, s50, v33
    v_mul_f32 v32, v33, v33
    v_mul_f32 v32, v32, v33
    v_mul_f32 v38, s51, v32
    v_lshlrev_b32 v5, 4, v28
    v_add_u32 v5, 0x25000, v5
    ds_write_b128 v5, v[36:39]
    s_branch k1_kernel_pdn
k1_kernel_pcs2:
    v_add_f32 v32, v32, v33
    v_add_f32 v32, v32, v34
    v_add_f32 v32, v32, v35
    v_add_f32 v32, v32, v36
    v_add_f32 v32, v32, v37
    v_add_f32 v32, v32, v38
    v_add_f32 v32, v32, v39
    v_add_f32 v32, v32, v40
    v_add_f32 v32, v32, v41
    v_add_f32 v32, v32, v42
    v_add_f32 v32, v32, v43
    v_add_f32 v32, v32, v44
    v_add_f32 v32, v32, v45
    v_add_f32 v32, v32, v46
    v_add_f32 v32, v32, v47
    v_lshlrev_b32 v5, 2, v2
    v_add_u32 v5, 0x24800, v5
    ds_write_b32 v5, v32
k1_kernel_pdn:
    s_waitcnt lgkmcnt(0)
    s_barrier
k1_kernel_store:
    s_barrier
    v_and_b32 v2, 63, v0
    s_lshl_b32 s44, s32, 7
    s_add_u32 s44, s44, 0
    v_add_u32 v5, s44, v2
    v_lshrrev_b32 v3, 3, v5
    v_and_b32 v4, 7, v5
    v_mul_u32_u24 v6, 144, v3
    v_lshl_add_u32 v6, v4, 4, v6
    ds_read_b128 v[32:35], v6
    s_lshl_b32 s44, s32, 7
    s_add_u32 s44, s44, 64
    v_add_u32 v5, s44, v2
    v_lshrrev_b32 v3, 3, v5
    v_and_b32 v4, 7, v5
    v_mul_u32_u24 v6, 144, v3
    v_lshl_add_u32 v6, v4, 4, v6
    ds_read_b128 v[36:39], v6
    s_waitcnt lgkmcnt(1)
    buffer_store_dwordx4 v[32:35], v248, s[20:23], 0 offen sc1
    s_waitcnt lgkmcnt(0)
    buffer_store_dwordx4 v[36:39], v249, s[20:23], 0 offen sc1
k1_kernel_fin:
    s_waitcnt vmcnt(0) lgkmcnt(0)
k1_kernel_finnw:
k1_kernel_pskip:
    s_barrier
    s_cmp_lg_u32 s32, 4
    s_cbranch_scc1 k2_kernel
    s_add_u32 s24, s70, 0x1b20000
    s_addc_u32 s25, s71, 0
    s_mov_b32 s26, 0x800
    s_mov_b32 s27, 0x20000
    s_lshl_b32 s44, s48, 4
    s_add_u32 s44, s44, s49
    s_lshl_b32 s44, s44, 3
    v_and_b32 v2, 63, v0
    v_mov_b32 v22, s44
    v_mov_b32 v23, 0x7ffffff0
    v_cmp_eq_u32 vcc, 0, v2
    v_mov_b32 v24, s6
    v_mov_b32 v25, s7
    v_cndmask_b32 v22, v23, v22, vcc
    buffer_store_dwordx2 v[24:25], v22, s[24:27], 0 offen sc1
    s_branch k2_kernel
k1_kernel_done:
    s_endpgm
k1_kernel_cons:
    s_cmp_lg_u32 s2, 0
    s_cbranch_scc1 k1_kernel_non
    s_cmp_lg_u32 s32, 1
    s_cbranch_scc1 k1_kernel_non
    s_memrealtime s[96:97]
    s_mov_b32 s72, s68
    s_mov_b32 s73, s69
    s_mov_b32 s74, 0x100
    s_mov_b32 s75, 0x20000
    s_waitcnt lgkmcnt(0)
    s_or_b32 s96, s96, 1
    v_mov_b32 v28, s96
    v_mov_b32 v29, s97
    v_mov_b32 v22, 0x7ffffff0
    v_cmp_eq_u32 vcc, 0, v2
    v_mov_b32 v23, 0
    s_nop 0
    v_cndmask_b32 v22, v22, v23, vcc
    buffer_store_dwordx2 v[28:29], v22, s[72:75], 0 offen sc1
k1_kernel_non:
    s_cmp_lg_u32 s32, 3
    s_cbranch_scc1 k1_kernel_cpf1_d
    s_getpc_b64 s[4:5]
k1_kernel_cpf1:
    s_sub_u32 s4, s4, k1_kernel_cpf1-k1_kernel
    s_subb_u32 s5, s5, 0
    s_and_b32 s44, s54, 1
    s_lshl_b32 s44, s44, 13
    v_lshlrev_b32 v6, 7, v2
    v_add_u32 v6, s44, v6
    v_min_u32 v6, k1_kernel_end-k1_kernel-4, v6
    global_load_dword v250, v6, s[4:5]
k1_kernel_cpf1_d:
    s_lshr_b32 s36, s32, 1
    s_and_b32 s37, s32, 1
    v_and_b32 v3, 15, v2
    v_lshrrev_b32 v4, 4, v2
    s_lshl_b32 s44, s36, 13
    v_lshlrev_b32 v5, 7, v3
    v_lshrrev_b32 v6, 1, v3
    v_xor_b32 v6, v6, v4
    v_lshlrev_b32 v6, 4, v6
    v_add3_u32 v8, v5, v6, s44
    v_xor_b32 v9, 64, v8
    v_lshrrev_b32 v5, 2, v3
    v_lshl_add_u32 v6, v4, 3, v5
    v_and_b32 v7, 3, v2
    v_lshlrev_b32 v6, 7, v6
    v_lshl_add_u32 v6, v7, 3, v6
    v_lshrrev_b32 v5, 1, v5
    v_and_b32 v7, 1, v4
    v_lshl_or_b32 v5, v7, 1, v5
    s_lshl_b32 s44, s37, 1
    v_xor_b32 v5, s44, v5
    v_lshl_add_u32 v6, v5, 5, v6
    v_add_u32 v12, 16384, v6
    v_xor_b32 v13, 32, v12
    v_mov_b32 v128, 0
    v_mov_b32 v129, 0
    v_mov_b32 v130, 0
    v_mov_b32 v131, 0
    v_mov_b32 v132, 0
    v_mov_b32 v133, 0
    v_mov_b32 v134, 0
    v_mov_b32 v135, 0
    v_mov_b32 v136, 0
    v_mov_b32 v137, 0
    v_mov_b32 v138, 0
    v_mov_b32 v139, 0
    v_mov_b32 v140, 0
    v_mov_b32 v141, 0
    v_mov_b32 v142, 0
    v_mov_b32 v143, 0
    v_mov_b32 v144, 0
    v_mov_b32 v145, 0
    v_mov_b32 v146, 0
    v_mov_b32 v147, 0
    v_mov_b32 v148, 0
    v_mov_b32 v149, 0
    v_mov_b32 v150, 0
    v_mov_b32 v151, 0
    v_mov_b32 v152, 0
    v_mov_b32 v153, 0
    v_mov_b32 v154, 0
    v_mov_b32 v155, 0
    v_mov_b32 v156, 0
    v_mov_b32 v157, 0
    v_mov_b32 v158, 0
    v_mov_b32 v159, 0
    v_mov_b32 v176, 0
    v_mov_b32 v177, 0
    v_mov_b32 v178, 0
    v_mov_b32 v179, 0
    v_mov_b32 v180, 0
    v_mov_b32 v181, 0
    v_mov_b32 v182, 0
    v_mov_b32 v183, 0
    v_mov_b32 v184, 0
    v_mov_b32 v185, 0
    v_mov_b32 v186, 0
    v_mov_b32 v187, 0
    v_mov_b32 v188, 0
    v_mov_b32 v189, 0
    v_mov_b32 v190, 0
    v_mov_b32 v191, 0
    v_mov_b32 v192, 0
    v_mov_b32 v193, 0
    v_mov_b32 v194, 0
    v_mov_b32 v195, 0
    v_mov_b32 v196, 0x3f803f80
    v_mov_b32 v197, 0x3f803f80
    v_mov_b32 v198, 0x3f803f80
    v_mov_b32 v199, 0x3f803f80
    s_mov_b32 s20, s70
    s_mov_b32 s21, s71
    s_mov_b32 s22, 0x440000
    s_mov_b32 s23, 0x20000
    s_add_u32 s24, s70, 0x1a80000
    s_addc_u32 s25, s71, 0
    s_mov_b32 s26, 0x40000
    s_mov_b32 s27, 0x20000
    s_add_u32 s28, s70, 0x1ac0000
    s_addc_u32 s29, s71, 0
    s_mov_b32 s30, 0x10000
    s_mov_b32 s31, 0x20000
    s_lshl_b32 s44, s32, 7
    s_add_u32 s44, s44, 0
    v_add_u32 v5, s44, v2
    v_lshrrev_b32 v3, 3, v5
    v_and_b32 v4, 7, v5
    v_add_u32 v3, s33, v3
    v_lshlrev_b32 v4, 4, v4
    s_lshl_b32 s45, s34, 1
    v_add_u32 v4, s45, v4
    v_mul_u32_u24 v5, 2176, v3
    v_add_u32 v248, v5, v4
    s_lshl_b32 s44, s32, 7
    s_add_u32 s44, s44, 64
    v_add_u32 v5, s44, v2
    v_lshrrev_b32 v3, 3, v5
    v_and_b32 v4, 7, v5
    v_add_u32 v3, s33, v3
    v_lshlrev_b32 v4, 4, v4
    s_lshl_b32 s45, s34, 1
    v_add_u32 v4, s45, v4
    v_mul_u32_u24 v5, 2176, v3
    v_add_u32 v249, v5, v4
    s_mov_b32 s41, 0
    s_barrier
    v_add_u32 v10, s41, v8
    v_add_u32 v11, s41, v9
    v_add_u32 v16, s41, v12
    v_add_u32 v17, s41, v13
    ds_read_b128 v[32:35], v10 offset:0
    ds_read_b64_tr_b16 v[48:49], v16 offset:0
    ds_read_b64_tr_b16 v[50:51], v16 offset:512
    ds_read_b128 v[36:39], v10 offset:2048
    ds_read_b128 v[40:43], v10 offset:4096
    ds_read_b128 v[44:47], v10 offset:6144
    ds_read_b64_tr_b16 v[52:53], v17 offset:0
    ds_read_b64_tr_b16 v[54:55], v17 offset:512
    s_cmp_lg_u32 s32, 0
    s_cbranch_scc1 k1_kernel_pver1
    s_waitcnt lgkmcnt(0)
    v_mfma_f32_16x16x32_bf16 v[176:179], v[196:199], v[32:35], v[176:179]
    ds_read_b128 v[56:59], v11 offset:0
    v_mfma_f32_16x16x32_bf16 v[184:187], v[32:35], v[32:35], v[184:187]
    ds_read_b64_tr_b16 v[72:73], v16 offset:4096
    v_mfma_f32_16x16x32_bf16 v[180:183], v[196:199], v[36:39], v[180:183]
    ds_read_b64_tr_b16 v[74:75], v16 offset:4608
    v_mfma_f32_16x16x32_bf16 v[188:191], v[36:39], v[36:39], v[188:191]
    ds_read_b128 v[60:63], v11 offset:2048
    v_mfma_f32_16x16x32_bf16 v[192:195], v[48:51], v[196:199], v[192:195]
    ds_read_b128 v[64:67], v11 offset:4096
    v_mfma_f32_16x16x32_bf16 v[128:131], v[48:51], v[32:35], v[128:131]
    ds_read_b128 v[68:71], v11 offset:6144
    v_mfma_f32_16x16x32_bf16 v[136:139], v[48:51], v[36:39], v[136:139]
    ds_read_b64_tr_b16 v[76:77], v17 offset:4096
    v_mfma_f32_16x16x32_bf16 v[144:147], v[48:51], v[40:43], v[144:147]
    ds_read_b64_tr_b16 v[78:79], v17 offset:4608
    v_mfma_f32_16x16x32_bf16 v[152:155], v[48:51], v[44:47], v[152:155]
    v_mfma_f32_16x16x32_bf16 v[132:135], v[52:55], v[32:35], v[132:135]
    v_mfma_f32_16x16x32_bf16 v[140:143], v[52:55], v[36:39], v[140:143]
    v_mfma_f32_16x16x32_bf16 v[148:151], v[52:55], v[40:43], v[148:151]
    v_mfma_f32_16x16x32_bf16 v[156:159], v[52:55], v[44:47], v[156:159]
    s_mov_b32 s41, 24576
    v_add_u32 v10, s41, v8
    v_add_u32 v16, s41, v12
    v_add_u32 v17, s41, v13
    s_waitcnt lgkmcnt(0)
    s_barrier
    v_mfma_f32_16x16x32_bf16 v[176:179], v[196:199], v[56:59], v[176:179]
    ds_read_b128 v[32:35], v10 offset:0
    v_mfma_f32_16x16x32_bf16 v[184:187], v[56:59], v[56:59], v[184:187]
    ds_read_b64_tr_b16 v[48:49], v16 offset:0
    v_mfma_f32_16x16x32_bf16 v[180:183], v[196:199], v[60:63], v[180:183]
    ds_read_b64_tr_b16 v[50:51], v16 offset:512
    v_mfma_f32_16x16x32_bf16 v[188:191], v[60:63], v[60:63], v[188:191]
    ds_read_b128 v[36:39], v10 offset:2048
    v_mfma_f32_16x16x32_bf16 v[192:195], v[72:75], v[196:199], v[192:195]
    ds_read_b128 v[40:43], v10 offset:4096
    v_mfma_f32_16x16x32_bf16 v[128:131], v[72:75], v[56:59], v[128:131]
    ds_read_b128 v[44:47], v10 offset:6144
    v_mfma_f32_16x16x32_bf16 v[136:139], v[72:75], v[60:63], v[136:139]
    ds_read_b64_tr_b16 v[52:53], v17 offset:0
    v_mfma_f32_16x16x32_bf16 v[144:147], v[72:75], v[64:67], v[144:147]
    ds_read_b64_tr_b16 v[54:55], v17 offset:512
    v_mfma_f32_16x16x32_bf16 v[152:155], v[72:75], v[68:71], v[152:155]
    v_mfma_f32_16x16x32_bf16 v[132:135], v[76:79], v[56:59], v[132:135]
    v_mfma_f32_16x16x32_bf16 v[140:143], v[76:79], v[60:63], v[140:143]
    v_mfma_f32_16x16x32_bf16 v[148:151], v[76:79], v[64:67], v[148:151]
    v_mfma_f32_16x16x32_bf16 v[156:159], v[76:79], v[68:71], v[156:159]
    s_branch k1_kernel_pub
k1_kernel_pver1:
    s_cmp_lg_u32 s32, 1
    s_cbranch_scc1 k1_kernel_pver2
    s_waitcnt lgkmcnt(0)
    v_mfma_f32_16x16x32_bf16 v[176:179], v[196:199], v[40:43], v[176:179]
    ds_read_b128 v[56:59], v11 offset:0
    v_mfma_f32_16x16x32_bf16 v[184:187], v[40:43], v[40:43], v[184:187]
    ds_read_b64_tr_b16 v[72:73], v16 offset:4096
    v_mfma_f32_16x16x32_bf16 v[180:183], v[196:199], v[44:47], v[180:183]
    ds_read_b64_tr_b16 v[74:75], v16 offset:4608
    v_mfma_f32_16x16x32_bf16 v[188:191], v[44:47], v[44:47], v[188:191]
    ds_read_b128 v[60:63], v11 offset:2048
    v_mfma_f32_16x16x32_bf16 v[192:195], v[48:51], v[196:199], v[192:195]
    ds_read_b128 v[64:67], v11 offset:4096
    v_mfma_f32_16x16x32_bf16 v[128:131], v[48:51], v[32:35], v[128:131]
    ds_read_b128 v[68:71], v11 offset:6144
    v_mfma_f32_16x16x32_bf16 v[136:139], v[48:51], v[36:39], v[136:139]
    ds_read_b64_tr_b16 v[76:77], v17 offset:4096
    v_mfma_f32_16x16x32_bf16 v[144:147], v[48:51], v[40:43], v[144:147]
    ds_read_b64_tr_b16 v[78:79], v17 offset:4608
    v_mfma_f32_16x16x32_bf16 v[152:155], v[48:51], v[44:47], v[152:155]
    v_mfma_f32_16x16x32_bf16 v[132:135], v[52:55], v[32:35], v[132:135]
    v_mfma_f32_16x16x32_bf16 v[140:143], v[52:55], v[36:39], v[140:143]
    v_mfma_f32_16x16x32_bf16 v[148:151], v[52:55], v[40:43], v[148:151]
    v_mfma_f32_16x16x32_bf16 v[156:159], v[52:55], v[44:47], v[156:159]
    s_mov_b32 s41, 24576
    v_add_u32 v10, s41, v8
    v_add_u32 v16, s41, v12
    v_add_u32 v17, s41, v13
    s_waitcnt lgkmcnt(0)
    s_barrier
    v_mfma_f32_16x16x32_bf16 v[176:179], v[196:199], v[64:67], v[176:179]
    ds_read_b128 v[32:35], v10 offset:0
    v_mfma_f32_16x16x32_bf16 v[184:187], v[64:67], v[64:67], v[184:187]
    ds_read_b64_tr_b16 v[48:49], v16 offset:0
    v_mfma_f32_16x16x32_bf16 v[180:183], v[196:199], v[68:71], v[180:183]
    ds_read_b64_tr_b16 v[50:51], v16 offset:512
    v_mfma_f32_16x16x32_bf16 v[188:191], v[68:71], v[68:71], v[188:191]
    ds_read_b128 v[36:39], v10 offset:2048
    v_mfma_f32_16x16x32_bf16 v[192:195], v[72:75], v[196:199], v[192:195]
    ds_read_b128 v[40:43], v10 offset:4096
    v_mfma_f32_16x16x32_bf16 v[128:131], v[72:75], v[56:59], v[128:131]
    ds_read_b128 v[44:47], v10 offset:6144
    v_mfma_f32_16x16x32_bf16 v[136:139], v[72:75], v[60:63], v[136:139]
    ds_read_b64_tr_b16 v[52:53], v17 offset:0
    v_mfma_f32_16x16x32_bf16 v[144:147], v[72:75], v[64:67], v[144:147]
    ds_read_b64_tr_b16 v[54:55], v17 offset:512
    v_mfma_f32_16x16x32_bf16 v[152:155], v[72:75], v[68:71], v[152:155]
    v_mfma_f32_16x16x32_bf16 v[132:135], v[76:79], v[56:59], v[132:135]
    v_mfma_f32_16x16x32_bf16 v[140:143], v[76:79], v[60:63], v[140:143]
    v_mfma_f32_16x16x32_bf16 v[148:151], v[76:79], v[64:67], v[148:151]
    v_mfma_f32_16x16x32_bf16 v[156:159], v[76:79], v[68:71], v[156:159]
    s_branch k1_kernel_pub
k1_kernel_pver2:
    s_cmp_lg_u32 s32, 2
    s_cbranch_scc1 k1_kernel_pver3
    s_waitcnt lgkmcnt(0)
    v_mfma_f32_16x16x32_bf16 v[176:179], v[196:199], v[32:35], v[176:179]
    ds_read_b128 v[56:59], v11 offset:0
    v_mfma_f32_16x16x32_bf16 v[184:187], v[32:35], v[32:35], v[184:187]
    ds_read_b64_tr_b16 v[72:73], v16 offset:4096
    v_mfma_f32_16x16x32_bf16 v[180:183], v[196:199], v[36:39], v[180:183]
    ds_read_b64_tr_b16 v[74:75], v16 offset:4608
    v_mfma_f32_16x16x32_bf16 v[188:191], v[36:39], v[36:39], v[188:191]
    ds_read_b128 v[60:63], v11 offset:2048
    v_mfma_f32_16x16x32_bf16 v[192:195], v[52:55], v[196:199], v[192:195]
    ds_read_b128 v[64:67], v11 offset:4096
    v_mfma_f32_16x16x32_bf16 v[128:131], v[48:51], v[32:35], v[128:131]
    ds_read_b128 v[68:71], v11 offset:6144
    v_mfma_f32_16x16x32_bf16 v[136:139], v[48:51], v[36:39], v[136:139]
    ds_read_b64_tr_b16 v[76:77], v17 offset:4096
    v_mfma_f32_16x16x32_bf16 v[144:147], v[48:51], v[40:43], v[144:147]
    ds_read_b64_tr_b16 v[78:79], v17 offset:4608
    v_mfma_f32_16x16x32_bf16 v[152:155], v[48:51], v[44:47], v[152:155]
    v_mfma_f32_16x16x32_bf16 v[132:135], v[52:55], v[32:35], v[132:135]
    v_mfma_f32_16x16x32_bf16 v[140:143], v[52:55], v[36:39], v[140:143]
    v_mfma_f32_16x16x32_bf16 v[148:151], v[52:55], v[40:43], v[148:151]
    v_mfma_f32_16x16x32_bf16 v[156:159], v[52:55], v[44:47], v[156:159]
    s_mov_b32 s41, 24576
    v_add_u32 v10, s41, v8
    v_add_u32 v16, s41, v12
    v_add_u32 v17, s41, v13
    s_waitcnt lgkmcnt(0)
    s_barrier
    v_mfma_f32_16x16x32_bf16 v[176:179], v[196:199], v[56:59], v[176:179]
    ds_read_b128 v[32:35], v10 offset:0
    v_mfma_f32_16x16x32_bf16 v[184:187], v[56:59], v[56:59], v[184:187]
    ds_read_b64_tr_b16 v[48:49], v16 offset:0
    v_mfma_f32_16x16x32_bf16 v[180:183], v[196:199], v[60:63], v[180:183]
    ds_read_b64_tr_b16 v[50:51], v16 offset:512
    v_mfma_f32_16x16x32_bf16 v[188:191], v[60:63], v[60:63], v[188:191]
    ds_read_b128 v[36:39], v10 offset:2048
    v_mfma_f32_16x16x32_bf16 v[192:195], v[76:79], v[196:199], v[192:195]
    ds_read_b128 v[40:43], v10 offset:4096
    v_mfma_f32_16x16x32_bf16 v[128:131], v[72:75], v[56:59], v[128:131]
    ds_read_b128 v[44:47], v10 offset:6144
    v_mfma_f32_16x16x32_bf16 v[136:139], v[72:75], v[60:63], v[136:139]
    ds_read_b64_tr_b16 v[52:53], v17 offset:0
    v_mfma_f32_16x16x32_bf16 v[144:147], v[72:75], v[64:67], v[144:147]
    ds_read_b64_tr_b16 v[54:55], v17 offset:512
    v_mfma_f32_16x16x32_bf16 v[152:155], v[72:75], v[68:71], v[152:155]
    v_mfma_f32_16x16x32_bf16 v[132:135], v[76:79], v[56:59], v[132:135]
    v_mfma_f32_16x16x32_bf16 v[140:143], v[76:79], v[60:63], v[140:143]
    v_mfma_f32_16x16x32_bf16 v[148:151], v[76:79], v[64:67], v[148:151]
    v_mfma_f32_16x16x32_bf16 v[156:159], v[76:79], v[68:71], v[156:159]
    s_branch k1_kernel_pub
k1_kernel_pver3:
    s_waitcnt lgkmcnt(0)
    v_mfma_f32_16x16x32_bf16 v[176:179], v[196:199], v[40:43], v[176:179]
    ds_read_b128 v[56:59], v11 offset:0
    v_mfma_f32_16x16x32_bf16 v[184:187], v[40:43], v[40:43], v[184:187]
    ds_read_b64_tr_b16 v[72:73], v16 offset:4096
    v_mfma_f32_16x16x32_bf16 v[180:183], v[196:199], v[44:47], v[180:183]
    ds_read_b64_tr_b16 v[74:75], v16 offset:4608
    v_mfma_f32_16x16x32_bf16 v[188:191], v[44:47], v[44:47], v[188:191]
    ds_read_b128 v[60:63], v11 offset:2048
    v_mfma_f32_16x16x32_bf16 v[192:195], v[52:55], v[196:199], v[192:195]
    ds_read_b128 v[64:67], v11 offset:4096
    v_mfma_f32_16x16x32_bf16 v[128:131], v[48:51], v[32:35], v[128:131]
    ds_read_b128 v[68:71], v11 offset:6144
    v_mfma_f32_16x16x32_bf16 v[136:139], v[48:51], v[36:39], v[136:139]
    ds_read_b64_tr_b16 v[76:77], v17 offset:4096
    v_mfma_f32_16x16x32_bf16 v[144:147], v[48:51], v[40:43], v[144:147]
    ds_read_b64_tr_b16 v[78:79], v17 offset:4608
    v_mfma_f32_16x16x32_bf16 v[152:155], v[48:51], v[44:47], v[152:155]
    v_mfma_f32_16x16x32_bf16 v[132:135], v[52:55], v[32:35], v[132:135]
    v_mfma_f32_16x16x32_bf16 v[140:143], v[52:55], v[36:39], v[140:143]
    v_mfma_f32_16x16x32_bf16 v[148:151], v[52:55], v[40:43], v[148:151]
    v_mfma_f32_16x16x32_bf16 v[156:159], v[52:55], v[44:47], v[156:159]
    s_mov_b32 s41, 24576
    v_add_u32 v10, s41, v8
    v_add_u32 v16, s41, v12
    v_add_u32 v17, s41, v13
    s_waitcnt lgkmcnt(0)
    s_barrier
    v_mfma_f32_16x16x32_bf16 v[176:179], v[196:199], v[64:67], v[176:179]
    ds_read_b128 v[32:35], v10 offset:0
    v_mfma_f32_16x16x32_bf16 v[184:187], v[64:67], v[64:67], v[184:187]
    ds_read_b64_tr_b16 v[48:49], v16 offset:0
    v_mfma_f32_16x16x32_bf16 v[180:183], v[196:199], v[68:71], v[180:183]
    ds_read_b64_tr_b16 v[50:51], v16 offset:512
    v_mfma_f32_16x16x32_bf16 v[188:191], v[68:71], v[68:71], v[188:191]
    ds_read_b128 v[36:39], v10 offset:2048
    v_mfma_f32_16x16x32_bf16 v[192:195], v[76:79], v[196:199], v[192:195]
    ds_read_b128 v[40:43], v10 offset:4096
    v_mfma_f32_16x16x32_bf16 v[128:131], v[72:75], v[56:59], v[128:131]
    ds_read_b128 v[44:47], v10 offset:6144
    v_mfma_f32_16x16x32_bf16 v[136:139], v[72:75], v[60:63], v[136:139]
    ds_read_b64_tr_b16 v[52:53], v17 offset:0
    v_mfma_f32_16x16x32_bf16 v[144:147], v[72:75], v[64:67], v[144:147]
    ds_read_b64_tr_b16 v[54:55], v17 offset:512
    v_mfma_f32_16x16x32_bf16 v[152:155], v[72:75], v[68:71], v[152:155]
    v_mfma_f32_16x16x32_bf16 v[132:135], v[76:79], v[56:59], v[132:135]
    v_mfma_f32_16x16x32_bf16 v[140:143], v[76:79], v[60:63], v[140:143]
    v_mfma_f32_16x16x32_bf16 v[148:151], v[76:79], v[64:67], v[148:151]
    v_mfma_f32_16x16x32_bf16 v[156:159], v[76:79], v[68:71], v[156:159]
    s_branch k1_kernel_pub
k1_kernel_pub:
    v_add_u32 v11, s41, v9
    v_and_b32 v22, 15, v2
    s_mov_b32 s96, 0x22222222
    s_mov_b32 s97, 0x22222222
    s_mov_b32 s98, 0x44444444
    s_mov_b32 s99, 0x44444444
    s_mov_b32 s100, 0x88888888
    s_mov_b32 s101, 0x88888888
    s_lshl_b32 s44, s36, 6
    s_lshl_b32 s45, s37, 5
    s_add_u32 s44, s44, s45
    s_add_u32 s44, s44, s33
    v_add_u32 v22, s44, v22
    v_lshlrev_b32 v22, 3, v22
    s_lshl_b32 s45, s49, 14
    v_add_u32 v22, s45, v22
    v_mov_b32 v23, 0x7ffffff0
    s_mov_b32 s4, 0x00f0000f
    s_mov_b32 s5, 0xf0000f00
    v_cndmask_b32 v22, v23, v22, s[4:5]
    v_mov_b32 v24, v176
    v_cndmask_b32 v25, v184, v185, s[96:97]
    v_cndmask_b32 v25, v25, v186, s[98:99]
    v_cndmask_b32 v25, v25, v187, s[100:101]
    buffer_store_dwordx2 v[24:25], v22, s[24:27], 0 offen offset:0 sc1
    v_mov_b32 v26, v180
    v_cndmask_b32 v27, v188, v189, s[96:97]
    v_cndmask_b32 v27, v27, v190, s[98:99]
    v_cndmask_b32 v27, v27, v191, s[100:101]
    buffer_store_dwordx2 v[26:27], v22, s[24:27], 0 offen offset:128 sc1
    s_lshl_b32 s44, s37, 1
    s_add_u32 s44, s44, s36
    s_lshl_b32 s44, s44, 6
    s_lshl_b32 s45, s49, 8
    s_add_u32 s44, s44, s45
    s_lshl_b32 s45, s48, 12
    s_add_u32 s44, s44, s45
    v_lshrrev_b32 v22, 4, v2
    v_lshlrev_b32 v22, 4, v22
    v_add_u32 v22, s44, v22
    s_mov_b32 s4, 0x00010001
    s_mov_b32 s5, 0x00010001
    v_cndmask_b32 v22, v23, v22, s[4:5]
    buffer_store_dwordx4 v[192:195], v22, s[28:31], 0 offen sc1
    s_mov_b32 s40, 15
k1_kernel_loop:
    s_cmp_eq_u32 s40, 15
    s_cbranch_scc1 k1_kernel_pfat0
k1_kernel_pfat0_r:
    s_cmp_eq_u32 s40, 14
    s_cbranch_scc1 k1_kernel_pfat1
k1_kernel_pfat1_r:
    s_cmp_eq_u32 s40, 13
    s_cbranch_scc1 k1_kernel_pfat2
k1_kernel_pfat2_r:
    s_cmp_eq_u32 s40, 8
    s_cbranch_scc1 k1_kernel_pfat3
k1_kernel_pfat3_r:
    s_cmp_eq_u32 s40, 7
    s_cbranch_scc1 k1_kernel_pfat4
k1_kernel_pfat4_r:
    s_cmp_eq_u32 s40, 5
    s_cbranch_scc1 k1_kernel_pfat5
k1_kernel_pfat5_r:
    s_cmp_eq_u32 s40, 4
    s_cbranch_scc1 k1_kernel_pfat6
k1_kernel_pfat6_r:
    s_cmp_eq_u32 s40, 3
    s_cbranch_scc1 k1_kernel_pfat7
k1_kernel_pfat7_r:
    s_cmp_eq_u32 s40, 2
    s_cbranch_scc1 k1_kernel_pfat8
k1_kernel_pfat8_r:
    s_cmp_eq_u32 s40, 2
    s_cbranch_scc1 k1_kernel_pfat9
k1_kernel_pfat9_r:
    s_cmp_eq_u32 s40, 1
    s_cbranch_scc1 k1_kernel_pfat10
k1_kernel_pfat10_r:
    s_waitcnt lgkmcnt(0)
    v_mfma_f32_16x16x32_bf16 v[128:131], v[48:51], v[32:35], v[128:131]
    ds_read_b128 v[56:59], v11 offset:0
    v_mfma_f32_16x16x32_bf16 v[136:139], v[48:51], v[36:39], v[136:139]
    ds_read_b64_tr_b16 v[72:73], v16 offset:4096
    v_mfma_f32_16x16x32_bf16 v[144:147], v[48:51], v[40:43], v[144:147]
    ds_read_b64_tr_b16 v[74:75], v16 offset:4608
    v_mfma_f32_16x16x32_bf16 v[152:155], v[48:51], v[44:47], v[152:155]
    ds_read_b128 v[60:63], v11 offset:2048
    v_mfma_f32_16x16x32_bf16 v[132:135], v[52:55], v[32:35], v[132:135]
    ds_read_b128 v[64:67], v11 offset:4096
    v_mfma_f32_16x16x32_bf16 v[140:143], v[52:55], v[36:39], v[140:143]
    ds_read_b128 v[68:71], v11 offset:6144
    v_mfma_f32_16x16x32_bf16 v[148:151], v[52:55], v[40:43], v[148:151]
    ds_read_b64_tr_b16 v[76:77], v17 offset:4096
    v_mfma_f32_16x16x32_bf16 v[156:159], v[52:55], v[44:47], v[156:159]
    ds_read_b64_tr_b16 v[78:79], v17 offset:4608
    s_add_u32 s41, s41, 24576
    s_cmp_eq_u32 s41, 147456
    s_cselect_b32 s41, 0, s41
    v_add_u32 v10, s41, v8
    v_add_u32 v16, s41, v12
    v_add_u32 v17, s41, v13
    s_waitcnt lgkmcnt(0)
    s_barrier
    v_mfma_f32_16x16x32_bf16 v[128:131], v[72:75], v[56:59], v[128:131]
    ds_read_b128 v[32:35], v10 offset:0
    v_mfma_f32_16x16x32_bf16 v[136:139], v[72:75], v[60:63], v[136:139]
    ds_read_b64_tr_b16 v[48:49], v16 offset:0
    v_mfma_f32_16x16x32_bf16 v[144:147], v[72:75], v[64:67], v[144:147]
    ds_read_b64_tr_b16 v[50:51], v16 offset:512
    v_mfma_f32_16x16x32_bf16 v[152:155], v[72:75], v[68:71], v[152:155]
    ds_read_b128 v[36:39], v10 offset:2048
    v_mfma_f32_16x16x32_bf16 v[132:135], v[76:79], v[56:59], v[132:135]
    ds_read_b128 v[40:43], v10 offset:4096
    v_mfma_f32_16x16x32_bf16 v[140:143], v[76:79], v[60:63], v[140:143]
    ds_read_b128 v[44:47], v10 offset:6144
    v_mfma_f32_16x16x32_bf16 v[148:151], v[76:79], v[64:67], v[148:151]
    ds_read_b64_tr_b16 v[52:53], v17 offset:0
    v_mfma_f32_16x16x32_bf16 v[156:159], v[76:79], v[68:71], v[156:159]
    ds_read_b64_tr_b16 v[54:55], v17 offset:512
    v_add_u32 v11, s41, v9
    s_sub_u32 s40, s40, 1
    s_cmp_lg_u32 s40, 0
    s_cbranch_scc1 k1_kernel_loop
    s_branch k1_kernel_after
k1_kernel_pfat0:
    s_cmp_lg_u32 s32, 0
    s_cbranch_scc1 k1_kernel_pfat0_r
    s_mov_b32 s72, s68
    s_mov_b32 s73, s69
    s_mov_b32 s74, 0x100
    s_mov_b32 s75, 0x20000
    v_mov_b32 v22, 0
    buffer_load_dwordx2 v[28:29], v22, s[72:75], 0 offen sc1
    s_branch k1_kernel_pfat0_r
k1_kernel_pfat1:
    s_waitcnt vmcnt(0)
    s_branch k1_kernel_pfat1_r
k1_kernel_pfat2:
    s_cmp_lg_u32 s32, 0
    s_cbranch_scc1 k1_kernel_pfat2_r
    s_mov_b32 s72, s68
    s_mov_b32 s73, s69
    s_mov_b32 s74, 0x100
    s_mov_b32 s75, 0x20000
k1_kernel_pfat2_p:
    v_readfirstlane_b32 s44, v28
    s_nop 3
    s_bitcmp1_b32 s44, 0
    s_cbranch_scc1 k1_kernel_pfat2_k
    v_mov_b32 v22, 0
    buffer_load_dwordx2 v[28:29], v22, s[72:75], 0 offen sc1
    s_waitcnt vmcnt(0)
    s_branch k1_kernel_pfat2_p
k1_kernel_pfat2_k:
    s_add_u32 s72, s70, 0x1b10000
    s_addc_u32 s73, s71, 0
    s_mov_b32 s74, 0x8000
    s_mov_b32 s75, 0x20000
    s_lshl_b32 s44, s48, 4
    s_add_u32 s44, s44, s49
    s_lshl_b32 s44, s44, 7
    v_mov_b32 v22, s44
    v_mov_b32 v23, 0x7ffffff0
    v_cmp_eq_u32 vcc, 0, v2
    s_nop 1
    v_cndmask_b32 v22, v23, v22, vcc
    buffer_store_dwordx2 v[28:29], v22, s[72:75], 0 offen sc1
    s_branch k1_kernel_pfat2_r
k1_kernel_pfat3:
    s_cmp_lg_u32 s32, 3
    s_cbranch_scc1 k1_kernel_pfat3_r
    s_getpc_b64 s[4:5]
k1_kernel_cpf2:
    s_add_u32 s4, s4, k2_kernel-k1_kernel_cpf2
    s_addc_u32 s5, s5, 0
    s_and_b32 s44, s54, 1
    s_lshl_b32 s44, s44, 13
    v_lshlrev_b32 v6, 7, v2
    v_add_u32 v6, s44, v6
    v_min_u32 v6, k2_kernel_end-k2_kernel-4, v6
    global_load_dword v250, v6, s[4:5]
    s_branch k1_kernel_pfat3_r
k1_kernel_pfat4:
    s_cmp_lg_u32 s32, 3
    s_cbranch_scc1 k1_kernel_pfat4_r
    s_getpc_b64 s[4:5]
k1_kernel_cpf3:
    s_sub_u32 s4, s4, k1_kernel_cpf3-k1_kernel
    s_subb_u32 s5, s5, 0
    s_and_b32 s44, s54, 1
    s_lshl_b32 s44, s44, 13
    v_lshlrev_b32 v6, 7, v2
    v_add_u32 v6, s44, v6
    v_min_u32 v6, k1_kernel_end-k1_kernel-4, v6
    global_load_dword v250, v6, s[4:5]
    s_branch k1_kernel_pfat4_r
k1_kernel_pfat5:
    s_cmp_lg_u32 s32, 0
    s_cbranch_scc1 k1_kernel_pfat5_r
    s_mov_b32 s72, s60
    s_mov_b32 s73, s61
    s_mov_b32 s74, 0x200000
    s_mov_b32 s75, 0x20000
    s_lshr_b32 s44, s53, 0
    s_and_b32 s44, s44, 0
    s_mul_i32 s44, s44, 0
    s_mul_i32 s45, s54, 32
    s_add_u32 s44, s44, s45
    s_mul_i32 s45, s32, 8
    s_add_u32 s44, s44, s45
    s_lshr_b32 s45, s53, 0
    s_and_b32 s45, s45, 1
    s_mul_i32 s45, s45, 1024
    v_lshrrev_b32 v6, 3, v2
    v_add_u32 v6, s44, v6
    s_mov_b32 s46, 2048
    v_mul_lo_u32 v6, v6, s46
    v_and_b32 v7, 7, v2
    v_lshl_add_u32 v6, v7, 7, v6
    v_add_u32 v6, s45, v6
    s_mov_b32 s46, 0
    buffer_load_dword v250, v6, s[72:75], s46 offen
    s_branch k1_kernel_pfat5_r
k1_kernel_pfat6:
    s_cmp_lg_u32 s32, 1
    s_cbranch_scc1 k1_kernel_pfat6_r
    s_mov_b32 s72, s60
    s_mov_b32 s73, s61
    s_mov_b32 s74, 0x200000
    s_mov_b32 s75, 0x20000
    s_lshr_b32 s44, s53, 0
    s_and_b32 s44, s44, 0
    s_mul_i32 s44, s44, 0
    s_mul_i32 s45, s54, 32
    s_add_u32 s44, s44, s45
    s_mul_i32 s45, s32, 8
    s_add_u32 s44, s44, s45
    s_lshr_b32 s45, s53, 0
    s_and_b32 s45, s45, 1
    s_mul_i32 s45, s45, 1024
    v_lshrrev_b32 v6, 3, v2
    v_add_u32 v6, s44, v6
    s_mov_b32 s46, 2048
    v_mul_lo_u32 v6, v6, s46
    v_and_b32 v7, 7, v2
    v_lshl_add_u32 v6, v7, 7, v6
    v_add_u32 v6, s45, v6
    s_mov_b32 s46, 0
    buffer_load_dword v250, v6, s[72:75], s46 offen
    s_branch k1_kernel_pfat6_r
k1_kernel_pfat7:
    s_cmp_lg_u32 s32, 2
    s_cbranch_scc1 k1_kernel_pfat7_r
    s_mov_b32 s72, s60
    s_mov_b32 s73, s61
    s_mov_b32 s74, 0x200000
    s_mov_b32 s75, 0x20000
    s_lshr_b32 s44, s53, 0
    s_and_b32 s44, s44, 0
    s_mul_i32 s44, s44, 0
    s_mul_i32 s45, s54, 32
    s_add_u32 s44, s44, s45
    s_mul_i32 s45, s32, 8
    s_add_u32 s44, s44, s45
    s_lshr_b32 s45, s53, 0
    s_and_b32 s45, s45, 1
    s_mul_i32 s45, s45, 1024
    v_lshrrev_b32 v6, 3, v2
    v_add_u32 v6, s44, v6
    s_mov_b32 s46, 2048
    v_mul_lo_u32 v6, v6, s46
    v_and_b32 v7, 7, v2
    v_lshl_add_u32 v6, v7, 7, v6
    v_add_u32 v6, s45, v6
    s_mov_b32 s46, 0
    buffer_load_dword v250, v6, s[72:75], s46 offen
    s_branch k1_kernel_pfat7_r
k1_kernel_pfat8:
    s_cmp_lg_u32 s32, 3
    s_cbranch_scc1 k1_kernel_pfat8_r
    s_mov_b32 s72, s60
    s_mov_b32 s73, s61
    s_mov_b32 s74, 0x200000
    s_mov_b32 s75, 0x20000
    s_lshr_b32 s44, s53, 0
    s_and_b32 s44, s44, 0
    s_mul_i32 s44, s44, 0
    s_mul_i32 s45, s54, 32
    s_add_u32 s44, s44, s45
    s_mul_i32 s45, s32, 8
    s_add_u32 s44, s44, s45
    s_lshr_b32 s45, s53, 0
    s_and_b32 s45, s45, 1
    s_mul_i32 s45, s45, 1024
    v_lshrrev_b32 v6, 3, v2
    v_add_u32 v6, s44, v6
    s_mov_b32 s46, 2048
    v_mul_lo_u32 v6, v6, s46
    v_and_b32 v7, 7, v2
    v_lshl_add_u32 v6, v7, 7, v6
    v_add_u32 v6, s45, v6
    s_mov_b32 s46, 0
    buffer_load_dword v250, v6, s[72:75], s46 offen
    s_branch k1_kernel_pfat8_r
k1_kernel_pfat9:
    s_cmp_lg_u32 s32, 0
    s_cbranch_scc1 k1_kernel_pfat9_r
    s_mov_b32 s72, s62
    s_mov_b32 s73, s63
    s_mov_b32 s74, 0x700000
    s_mov_b32 s75, 0x20000
    s_lshr_b32 s44, s53, 0
    s_and_b32 s44, s44, 7
    s_mul_i32 s44, s44, 128
    s_mul_i32 s45, s54, 4
    s_add_u32 s44, s44, s45
    s_mul_i32 s45, s32, 1
    s_add_u32 s44, s44, s45
    s_lshr_b32 s45, s53, 0
    s_and_b32 s45, s45, 0
    s_mul_i32 s45, s45, 0
    v_lshrrev_b32 v6, 6, v2
    v_add_u32 v6, s44, v6
    s_mov_b32 s46, 7168
    v_mul_lo_u32 v6, v6, s46
    v_and_b32 v7, 63, v2
    v_min_u32 v7, 55, v7
    v_lshl_add_u32 v6, v7, 7, v6
    v_add_u32 v6, s45, v6
    s_mov_b32 s46, 0
    buffer_load_dword v250, v6, s[72:75], s46 offen
    s_branch k1_kernel_pfat9_r
k1_kernel_pfat10:
    s_cmp_lg_u32 s32, 1
    s_cbranch_scc1 k1_kernel_pfat10_r
    s_mov_b32 s72, s62
    s_mov_b32 s73, s63
    s_mov_b32 s74, 0x700000
    s_mov_b32 s75, 0x20000
    s_lshr_b32 s44, s53, 0
    s_and_b32 s44, s44, 7
    s_mul_i32 s44, s44, 128
    s_mul_i32 s45, s54, 4
    s_add_u32 s44, s44, s45
    s_mul_i32 s45, s32, 1
    s_add_u32 s44, s44, s45
    s_lshr_b32 s45, s53, 0
    s_and_b32 s45, s45, 0
    s_mul_i32 s45, s45, 0
    v_lshrrev_b32 v6, 6, v2
    v_add_u32 v6, s44, v6
    s_mov_b32 s46, 7168
    v_mul_lo_u32 v6, v6, s46
    v_and_b32 v7, 63, v2
    v_min_u32 v7, 55, v7
    v_lshl_add_u32 v6, v7, 7, v6
    v_add_u32 v6, s45, v6
    s_mov_b32 s46, 0
    buffer_load_dword v250, v6, s[72:75], s46 offen
    s_branch k1_kernel_pfat10_r
k1_kernel_after:
    s_waitcnt lgkmcnt(0)
    s_nop 7
    s_nop 7
    v_and_b32 v3, 15, v2
    v_lshrrev_b32 v4, 4, v2
    s_mul_i32 s44, s36, 9216
    s_mul_i32 s45, s37, 64
    s_add_u32 s44, s44, s45
    v_mul_u32_u24 v5, 144, v3
    v_lshl_add_u32 v5, v4, 3, v5
    v_add_u32 v5, s44, v5
    s_lshl_b32 s44, s36, 6
    v_add_u32 v6, s44, v3
    v_lshlrev_b32 v6, 4, v6
    v_add_u32 v6, 0x25000, v6
    ds_read_b128 v[32:35], v6 offset:0
    ds_read_b128 v[36:39], v6 offset:256
    ds_read_b128 v[40:43], v6 offset:512
    ds_read_b128 v[44:47], v6 offset:768
    s_mul_i32 s44, s37, 128
    s_add_u32 s44, s44, 0x24800
    v_lshlrev_b32 v10, 4, v4
    v_add_u32 v10, s44, v10
    ds_read_b128 v[80:83], v10 offset:0
    ds_read_b128 v[84:87], v10 offset:64
    s_waitcnt lgkmcnt(0)
    v_pk_fma_f32 v[128:129], v[80:81], v[32:33], v[128:129] op_sel_hi:[1,0,1]
    v_pk_fma_f32 v[130:131], v[82:83], v[32:33], v[130:131] op_sel_hi:[1,0,1]
    v_pk_fma_f32 v[132:133], v[84:85], v[32:33], v[132:133] op_sel_hi:[1,0,1]
    v_pk_fma_f32 v[134:135], v[86:87], v[32:33], v[134:135] op_sel_hi:[1,0,1]
    v_pk_mul_f32 v[16:17], v[128:129], v[128:129]
    v_pk_mul_f32 v[18:19], v[130:131], v[130:131]
    v_pk_mul_f32 v[20:21], v[132:133], v[132:133]
    v_pk_mul_f32 v[22:23], v[134:135], v[134:135]
    v_pk_fma_f32 v[16:17], v[16:17], v[34:35], v[32:33] op_sel:[0,0,1] op_sel_hi:[1,0,1]
    v_pk_fma_f32 v[18:19], v[18:19], v[34:35], v[32:33] op_sel:[0,0,1] op_sel_hi:[1,0,1]
    v_pk_fma_f32 v[20:21], v[20:21], v[34:35], v[32:33] op_sel:[0,0,1] op_sel_hi:[1,0,1]
    v_pk_fma_f32 v[22:23], v[22:23], v[34:35], v[32:33] op_sel:[0,0,1] op_sel_hi:[1,0,1]
    v_pk_mul_f32 v[16:17], v[16:17], v[128:129]
    v_pk_mul_f32 v[18:19], v[18:19], v[130:131]
    v_pk_mul_f32 v[20:21], v[20:21], v[132:133]
    v_pk_mul_f32 v[22:23], v[22:23], v[134:135]
    v_exp_f32 v16, v16
    v_exp_f32 v17, v17
    v_exp_f32 v18, v18
    v_exp_f32 v19, v19
    v_exp_f32 v20, v20
    v_exp_f32 v21, v21
    v_exp_f32 v22, v22
    v_exp_f32 v23, v23
    v_pk_fma_f32 v[16:17], v[16:17], v[34:35], v[34:35] op_sel:[0,1,1] op_sel_hi:[1,1,1]
    v_pk_fma_f32 v[18:19], v[18:19], v[34:35], v[34:35] op_sel:[0,1,1] op_sel_hi:[1,1,1]
    v_pk_fma_f32 v[20:21], v[20:21], v[34:35], v[34:35] op_sel:[0,1,1] op_sel_hi:[1,1,1]
    v_pk_fma_f32 v[22:23], v[22:23], v[34:35], v[34:35] op_sel:[0,1,1] op_sel_hi:[1,1,1]
    v_rcp_f32 v16, v16
    v_rcp_f32 v17, v17
    v_rcp_f32 v18, v18
    v_rcp_f32 v19, v19
    v_rcp_f32 v20, v20
    v_rcp_f32 v21, v21
    v_rcp_f32 v22, v22
    v_rcp_f32 v23, v23
    v_pk_mul_f32 v[128:129], v[128:129], v[16:17]
    v_pk_mul_f32 v[130:131], v[130:131], v[18:19]
    v_pk_mul_f32 v[132:133], v[132:133], v[20:21]
    v_pk_mul_f32 v[134:135], v[134:135], v[22:23]
    v_cvt_pk_bf16_f32 v128, v128, v129
    v_cvt_pk_bf16_f32 v129, v130, v131
    v_cvt_pk_bf16_f32 v132, v132, v133
    v_cvt_pk_bf16_f32 v133, v134, v135
    ds_write_b64 v5, v[128:129] offset:0
    ds_write_b64 v5, v[132:133] offset:32
    v_pk_fma_f32 v[136:137], v[80:81], v[36:37], v[136:137] op_sel_hi:[1,0,1]
    v_pk_fma_f32 v[138:139], v[82:83], v[36:37], v[138:139] op_sel_hi:[1,0,1]
    v_pk_fma_f32 v[140:141], v[84:85], v[36:37], v[140:141] op_sel_hi:[1,0,1]
    v_pk_fma_f32 v[142:143], v[86:87], v[36:37], v[142:143] op_sel_hi:[1,0,1]
    v_pk_mul_f32 v[16:17], v[136:137], v[136:137]
    v_pk_mul_f32 v[18:19], v[138:139], v[138:139]
    v_pk_mul_f32 v[20:21], v[140:141], v[140:141]
    v_pk_mul_f32 v[22:23], v[142:143], v[142:143]
    v_pk_fma_f32 v[16:17], v[16:17], v[38:39], v[36:37] op_sel:[0,0,1] op_sel_hi:[1,0,1]
    v_pk_fma_f32 v[18:19], v[18:19], v[38:39], v[36:37] op_sel:[0,0,1] op_sel_hi:[1,0,1]
    v_pk_fma_f32 v[20:21], v[20:21], v[38:39], v[36:37] op_sel:[0,0,1] op_sel_hi:[1,0,1]
    v_pk_fma_f32 v[22:23], v[22:23], v[38:39], v[36:37] op_sel:[0,0,1] op_sel_hi:[1,0,1]
    v_pk_mul_f32 v[16:17], v[16:17], v[136:137]
    v_pk_mul_f32 v[18:19], v[18:19], v[138:139]
    v_pk_mul_f32 v[20:21], v[20:21], v[140:141]
    v_pk_mul_f32 v[22:23], v[22:23], v[142:143]
    v_exp_f32 v16, v16
    v_exp_f32 v17, v17
    v_exp_f32 v18, v18
    v_exp_f32 v19, v19
    v_exp_f32 v20, v20
    v_exp_f32 v21, v21
    v_exp_f32 v22, v22
    v_exp_f32 v23, v23
    v_pk_fma_f32 v[16:17], v[16:17], v[38:39], v[38:39] op_sel:[0,1,1] op_sel_hi:[1,1,1]
    v_pk_fma_f32 v[18:19], v[18:19], v[38:39], v[38:39] op_sel:[0,1,1] op_sel_hi:[1,1,1]
    v_pk_fma_f32 v[20:21], v[20:21], v[38:39], v[38:39] op_sel:[0,1,1] op_sel_hi:[1,1,1]
    v_pk_fma_f32 v[22:23], v[22:23], v[38:39], v[38:39] op_sel:[0,1,1] op_sel_hi:[1,1,1]
    v_rcp_f32 v16, v16
    v_rcp_f32 v17, v17
    v_rcp_f32 v18, v18
    v_rcp_f32 v19, v19
    v_rcp_f32 v20, v20
    v_rcp_f32 v21, v21
    v_rcp_f32 v22, v22
    v_rcp_f32 v23, v23
    v_pk_mul_f32 v[136:137], v[136:137], v[16:17]
    v_pk_mul_f32 v[138:139], v[138:139], v[18:19]
    v_pk_mul_f32 v[140:141], v[140:141], v[20:21]
    v_pk_mul_f32 v[142:143], v[142:143], v[22:23]
    v_cvt_pk_bf16_f32 v136, v136, v137
    v_cvt_pk_bf16_f32 v137, v138, v139
    v_cvt_pk_bf16_f32 v140, v140, v141
    v_cvt_pk_bf16_f32 v141, v142, v143
    ds_write_b64 v5, v[136:137] offset:2304
    ds_write_b64 v5, v[140:141] offset:2336
    v_pk_fma_f32 v[144:145], v[80:81], v[40:41], v[144:145] op_sel_hi:[1,0,1]
    v_pk_fma_f32 v[146:147], v[82:83], v[40:41], v[146:147] op_sel_hi:[1,0,1]
    v_pk_fma_f32 v[148:149], v[84:85], v[40:41], v[148:149] op_sel_hi:[1,0,1]
    v_pk_fma_f32 v[150:151], v[86:87], v[40:41], v[150:151] op_sel_hi:[1,0,1]
    v_pk_mul_f32 v[16:17], v[144:145], v[144:145]
    v_pk_mul_f32 v[18:19], v[146:147], v[146:147]
    v_pk_mul_f32 v[20:21], v[148:149], v[148:149]
    v_pk_mul_f32 v[22:23], v[150:151], v[150:151]
    v_pk_fma_f32 v[16:17], v[16:17], v[42:43], v[40:41] op_sel:[0,0,1] op_sel_hi:[1,0,1]
    v_pk_fma_f32 v[18:19], v[18:19], v[42:43], v[40:41] op_sel:[0,0,1] op_sel_hi:[1,0,1]
    v_pk_fma_f32 v[20:21], v[20:21], v[42:43], v[40:41] op_sel:[0,0,1] op_sel_hi:[1,0,1]
    v_pk_fma_f32 v[22:23], v[22:23], v[42:43], v[40:41] op_sel:[0,0,1] op_sel_hi:[1,0,1]
    v_pk_mul_f32 v[16:17], v[16:17], v[144:145]
    v_pk_mul_f32 v[18:19], v[18:19], v[146:147]
    v_pk_mul_f32 v[20:21], v[20:21], v[148:149]
    v_pk_mul_f32 v[22:23], v[22:23], v[150:151]
    v_exp_f32 v16, v16
    v_exp_f32 v17, v17
    v_exp_f32 v18, v18
    v_exp_f32 v19, v19
    v_exp_f32 v20, v20
    v_exp_f32 v21, v21
    v_exp_f32 v22, v22
    v_exp_f32 v23, v23
    v_pk_fma_f32 v[16:17], v[16:17], v[42:43], v[42:43] op_sel:[0,1,1] op_sel_hi:[1,1,1]
    v_pk_fma_f32 v[18:19], v[18:19], v[42:43], v[42:43] op_sel:[0,1,1] op_sel_hi:[1,1,1]
    v_pk_fma_f32 v[20:21], v[20:21], v[42:43], v[42:43] op_sel:[0,1,1] op_sel_hi:[1,1,1]
    v_pk_fma_f32 v[22:23], v[22:23], v[42:43], v[42:43] op_sel:[0,1,1] op_sel_hi:[1,1,1]
    v_rcp_f32 v16, v16
    v_rcp_f32 v17, v17
    v_rcp_f32 v18, v18
    v_rcp_f32 v19, v19
    v_rcp_f32 v20, v20
    v_rcp_f32 v21, v21
    v_rcp_f32 v22, v22
    v_rcp_f32 v23, v23
    v_pk_mul_f32 v[144:145], v[144:145], v[16:17]
    v_pk_mul_f32 v[146:147], v[146:147], v[18:19]
    v_pk_mul_f32 v[148:149], v[148:149], v[20:21]
    v_pk_mul_f32 v[150:151], v[150:151], v[22:23]
    v_cvt_pk_bf16_f32 v144, v144, v145
    v_cvt_pk_bf16_f32 v145, v146, v147
    v_cvt_pk_bf16_f32 v148, v148, v149
    v_cvt_pk_bf16_f32 v149, v150, v151
    ds_write_b64 v5, v[144:145] offset:4608
    ds_write_b64 v5, v[148:149] offset:4640
    v_pk_fma_f32 v[152:153], v[80:81], v[44:45], v[152:153] op_sel_hi:[1,0,1]
    v_pk_fma_f32 v[154:155], v[82:83], v[44:45], v[154:155] op_sel_hi:[1,0,1]
    v_pk_fma_f32 v[156:157], v[84:85], v[44:45], v[156:157] op_sel_hi:[1,0,1]
    v_pk_fma_f32 v[158:159], v[86:87], v[44:45], v[158:159] op_sel_hi:[1,0,1]
    v_pk_mul_f32 v[16:17], v[152:153], v[152:153]
    v_pk_mul_f32 v[18:19], v[154:155], v[154:155]
    v_pk_mul_f32 v[20:21], v[156:157], v[156:157]
    v_pk_mul_f32 v[22:23], v[158:159], v[158:159]
    v_pk_fma_f32 v[16:17], v[16:17], v[46:47], v[44:45] op_sel:[0,0,1] op_sel_hi:[1,0,1]
    v_pk_fma_f32 v[18:19], v[18:19], v[46:47], v[44:45] op_sel:[0,0,1] op_sel_hi:[1,0,1]
    v_pk_fma_f32 v[20:21], v[20:21], v[46:47], v[44:45] op_sel:[0,0,1] op_sel_hi:[1,0,1]
    v_pk_fma_f32 v[22:23], v[22:23], v[46:47], v[44:45] op_sel:[0,0,1] op_sel_hi:[1,0,1]
    v_pk_mul_f32 v[16:17], v[16:17], v[152:153]
    v_pk_mul_f32 v[18:19], v[18:19], v[154:155]
    v_pk_mul_f32 v[20:21], v[20:21], v[156:157]
    v_pk_mul_f32 v[22:23], v[22:23], v[158:159]
    v_exp_f32 v16, v16
    v_exp_f32 v17, v17
    v_exp_f32 v18, v18
    v_exp_f32 v19, v19
    v_exp_f32 v20, v20
    v_exp_f32 v21, v21
    v_exp_f32 v22, v22
    v_exp_f32 v23, v23
    v_pk_fma_f32 v[16:17], v[16:17], v[46:47], v[46:47] op_sel:[0,1,1] op_sel_hi:[1,1,1]
    v_pk_fma_f32 v[18:19], v[18:19], v[46:47], v[46:47] op_sel:[0,1,1] op_sel_hi:[1,1,1]
    v_pk_fma_f32 v[20:21], v[20:21], v[46:47], v[46:47] op_sel:[0,1,1] op_sel_hi:[1,1,1]
    v_pk_fma_f32 v[22:23], v[22:23], v[46:47], v[46:47] op_sel:[0,1,1] op_sel_hi:[1,1,1]
    v_rcp_f32 v16, v16
    v_rcp_f32 v17, v17
    v_rcp_f32 v18, v18
    v_rcp_f32 v19, v19
    v_rcp_f32 v20, v20
    v_rcp_f32 v21, v21
    v_rcp_f32 v22, v22
    v_rcp_f32 v23, v23
    v_pk_mul_f32 v[152:153], v[152:153], v[16:17]
    v_pk_mul_f32 v[154:155], v[154:155], v[18:19]
    v_pk_mul_f32 v[156:157], v[156:157], v[20:21]
    v_pk_mul_f32 v[158:159], v[158:159], v[22:23]
    v_cvt_pk_bf16_f32 v152, v152, v153
    v_cvt_pk_bf16_f32 v153, v154, v155
    v_cvt_pk_bf16_f32 v156, v156, v157
    v_cvt_pk_bf16_f32 v157, v158, v159
    ds_write_b64 v5, v[152:153] offset:6912
    ds_write_b64 v5, v[156:157] offset:6944
    s_waitcnt lgkmcnt(0)
    s_branch k1_kernel_store
k1_kernel_end:
k2_kernel:
    s_and_b32 s53, s2, 7
    s_lshr_b32 s54, s2, 3
    s_lshr_b32 s45, s53, 1
    s_and_b32 s45, s45, 3
    s_lshl_b32 s45, s45, 2
    s_lshr_b32 s46, s54, 3
    s_and_b32 s46, s46, 3
    s_add_u32 s48, s45, s46
    s_lshr_b32 s45, s53, 0
    s_and_b32 s45, s45, 1
    s_lshl_b32 s45, s45, 3
    s_lshr_b32 s46, s54, 0
    s_and_b32 s46, s46, 7
    s_add_u32 s49, s45, s46
    s_lshl_b32 s33, s48, 7
    s_mul_i32 s34, s49, 64
    v_lshrrev_b32 v1, 6, v0
    v_and_b32 v2, 63, v0
    s_nop 0
    v_readfirstlane_b32 s32, v1
    s_mov_b32 s50, 0xc0135761
    s_mov_b32 s51, 0xbdd2d3e8
    s_mov_b32 s52, 0xffff0000
    s_waitcnt lgkmcnt(0)
    s_mov_b32 s8, s70
    s_mov_b32 s9, s71
    s_mov_b32 s10, 0x440000
    s_mov_b32 s11, 0x20000
    s_mov_b32 s12, s60
    s_mov_b32 s13, s61
    s_mov_b32 s14, 0x200000
    s_mov_b32 s15, 0x20000
    s_cmp_lt_u32 s32, 4
    s_cbranch_scc1 k2_kernel_cons
k2_kernel_prod:
    s_sub_u32 s35, s32, 4
    v_lshrrev_b32 v3, 3, v2
    v_and_b32 v4, 7, v2
    v_lshrrev_b32 v5, 4, v2
    s_lshl_b32 s44, s35, 5
    s_add_u32 s44, s44, s33
    s_mov_b32 s45, 2176
    v_add_u32 v6, s44, v3
    v_mul_lo_u32 v6, v6, s45
    v_xor_b32 v7, v4, v5
    v_lshl_add_u32 v8, v7, 4, v6
    v_xor_b32 v7, 4, v7
    v_lshl_add_u32 v9, v7, 4, v6
    v_add_u32 v9, 17408, v9
    v_add_u32 v10, 34816, v8
    v_add_u32 v11, 34816, v9
    s_lshl_b32 s46, s34, 1
    s_mov_b32 s45, 2048
    s_lshl_b32 s44, s35, 4
    v_add_u32 v6, s44, v3
    v_mul_lo_u32 v6, v6, s45
    v_add_u32 v6, s46, v6
    v_and_b32 v7, 1, v5
    v_lshlrev_b32 v7, 1, v7
    v_xor_b32 v7, v4, v7
    v_lshl_add_u32 v12, v7, 4, v6
    v_xor_b32 v7, 4, v7
    v_lshl_add_u32 v13, v7, 4, v6
    v_add_u32 v13, 16384, v13
    s_lshl_b32 s42, s35, 12
    s_mul_i32 s43, s35, 2048
    s_add_u32 s43, s43, 16384
    s_mov_b32 s38, 0x0
    s_mov_b32 s39, 0x0
    s_add_u32 m0, s43, 0x0
    s_nop 0
    buffer_load_dwordx4 v12, s[12:15], s39 offen lds
    s_add_u32 m0, s43, 0x400
    s_nop 0
    buffer_load_dwordx4 v13, s[12:15], s39 offen lds
    s_mov_b32 s38, 0x80
    s_mov_b32 s39, 0x20000
    s_add_u32 m0, s43, 0x6000
    s_nop 0
    buffer_load_dwordx4 v12, s[12:15], s39 offen lds
    s_add_u32 m0, s43, 0x6400
    s_nop 0
    buffer_load_dwordx4 v13, s[12:15], s39 offen lds
    s_mov_b32 s38, 0x100
    s_mov_b32 s39, 0x40000
    s_add_u32 m0, s43, 0xc000
    s_nop 0
    buffer_load_dwordx4 v12, s[12:15], s39 offen lds
    s_add_u32 m0, s43, 0xc400
    s_nop 0
    buffer_load_dwordx4 v13, s[12:15], s39 offen lds
    s_mov_b32 s38, 0x180
    s_mov_b32 s39, 0x60000
    s_add_u32 m0, s43, 0x12000
    s_nop 0
    buffer_load_dwordx4 v12, s[12:15], s39 offen lds
    s_add_u32 m0, s43, 0x12400
    s_nop 0
    buffer_load_dwordx4 v13, s[12:15], s39 offen lds
    s_mov_b32 s38, 0x200
    s_mov_b32 s39, 0x80000
    s_add_u32 m0, s43, 0x18000
    s_nop 0
    buffer_load_dwordx4 v12, s[12:15], s39 offen lds
    s_add_u32 m0, s43, 0x18400
    s_nop 0
    buffer_load_dwordx4 v13, s[12:15], s39 offen lds
    s_mov_b32 s38, 0x280
    s_mov_b32 s39, 0xa0000
    s_add_u32 m0, s43, 0x1e000
    s_nop 0
    buffer_load_dwordx4 v12, s[12:15], s39 offen lds
    s_add_u32 m0, s43, 0x1e400
    s_nop 0
    buffer_load_dwordx4 v13, s[12:15], s39 offen lds
    s_cmp_lg_u32 s35, 0
    s_cbranch_scc1 k2_kernel_dok
    s_add_u32 s20, s70, 0x1b20000
    s_addc_u32 s21, s71, 0
    s_mov_b32 s22, 0x800
    s_mov_b32 s23, 0x20000
    v_and_b32 v26, 15, v2
    v_lshrrev_b32 v27, 4, v2
    v_min_u32 v27, 2, v27
    v_add_u32 v27, s48, v27
    v_max_u32 v27, 1, v27
    v_min_u32 v27, 16, v27
    v_subrev_u32 v27, 1, v27
    v_lshl_add_u32 v26, v27, 4, v26
    v_lshlrev_b32 v26, 3, v26
k2_kernel_dpoll:
    buffer_load_dwordx2 v[24:25], v26, s[20:23], 0 offen sc1
    s_waitcnt vmcnt(0)
    v_xor_b32 v24, s6, v24
    v_xor_b32 v25, s7, v25
    v_or_b32 v24, v24, v25
    v_cmp_ne_u32 vcc, 0, v24
    s_nop 4
    s_cmp_eq_u64 vcc, 0
    s_cbranch_scc0 k2_kernel_dpoll
k2_kernel_dok:
    s_barrier
    v_add_u32 v8, 0xfffff780, v8
    v_add_u32 v9, 0xfffff780, v9
    v_add_u32 v10, 0xfffff780, v10
    v_add_u32 v11, 0xfffff780, v11
    s_mov_b32 s38, 0x0
    s_mov_b32 s39, 0x0
    s_add_u32 m0, s42, 0x0
    s_nop 0
    buffer_load_dwordx4 v8, s[8:11], s38 offen sc1 lds
    s_add_u32 m0, s42, 0x400
    s_nop 0
    buffer_load_dwordx4 v9, s[8:11], s38 offen sc1 lds
    s_add_u32 m0, s42, 0x800
    s_nop 0
    buffer_load_dwordx4 v10, s[8:11], s38 offen sc1 lds
    s_add_u32 m0, s42, 0xc00
    s_nop 0
    buffer_load_dwordx4 v11, s[8:11], s38 offen sc1 lds
    s_mov_b32 s38, 0x80
    s_mov_b32 s39, 0x20000
    s_add_u32 m0, s42, 0x6000
    s_nop 0
    buffer_load_dwordx4 v8, s[8:11], s38 offen sc1 lds
    s_add_u32 m0, s42, 0x6400
    s_nop 0
    buffer_load_dwordx4 v9, s[8:11], s38 offen sc1 lds
    s_add_u32 m0, s42, 0x6800
    s_nop 0
    buffer_load_dwordx4 v10, s[8:11], s38 offen sc1 lds
    s_add_u32 m0, s42, 0x6c00
    s_nop 0
    buffer_load_dwordx4 v11, s[8:11], s38 offen sc1 lds
    s_add_u32 s20, s70, 0x500000
    s_addc_u32 s21, s71, 0
    s_mov_b32 s22, 0x440000
    s_mov_b32 s23, 0x20000
    s_mov_b32 s16, s56
    s_mov_b32 s17, s57
    s_mov_b32 s18, 0x400000
    s_mov_b32 s19, 0x20000
    s_add_u32 s24, s70, 0x1a00000
    s_addc_u32 s25, s71, 0
    s_mov_b32 s26, 0x40000
    s_mov_b32 s27, 0x20000
    s_add_u32 s28, s70, 0x1a40000
    s_addc_u32 s29, s71, 0
    s_mov_b32 s30, 0x38000
    s_mov_b32 s31, 0x20000
    s_waitcnt vmcnt(4)
    s_barrier
    s_mov_b32 s38, 0x100
    s_mov_b32 s39, 0x40000
    s_add_u32 m0, s42, 0xc000
    s_nop 0
    buffer_load_dwordx4 v8, s[8:11], s38 offen sc1 lds
    s_add_u32 m0, s42, 0xc400
    s_nop 0
    buffer_load_dwordx4 v9, s[8:11], s38 offen sc1 lds
    s_add_u32 m0, s42, 0xc800
    s_nop 0
    buffer_load_dwordx4 v10, s[8:11], s38 offen sc1 lds
    s_add_u32 m0, s42, 0xcc00
    s_nop 0
    buffer_load_dwordx4 v11, s[8:11], s38 offen sc1 lds
    s_mov_b32 s38, 0x180
    s_mov_b32 s39, 0x60000
    s_add_u32 m0, s42, 0x12000
    s_nop 0
    buffer_load_dwordx4 v8, s[8:11], s38 offen sc1 lds
    s_add_u32 m0, s42, 0x12400
    s_nop 0
    buffer_load_dwordx4 v9, s[8:11], s38 offen sc1 lds
    s_add_u32 m0, s42, 0x12800
    s_nop 0
    buffer_load_dwordx4 v10, s[8:11], s38 offen sc1 lds
    s_add_u32 m0, s42, 0x12c00
    s_nop 0
    buffer_load_dwordx4 v11, s[8:11], s38 offen sc1 lds
    s_waitcnt vmcnt(8)
    s_barrier
    v_add_u32 v8, 0x1100, v8
    v_add_u32 v9, 0x1100, v9
    v_add_u32 v10, 0x1100, v10
    v_add_u32 v11, 0x1100, v11
    s_mov_b32 s38, 0x200
    s_mov_b32 s39, 0x80000
    s_add_u32 m0, s42, 0x18000
    s_nop 0
    buffer_load_dwordx4 v8, s[8:11], s38 offen sc1 lds
    s_add_u32 m0, s42, 0x18400
    s_nop 0
    buffer_load_dwordx4 v9, s[8:11], s38 offen sc1 lds
    s_add_u32 m0, s42, 0x18800
    s_nop 0
    buffer_load_dwordx4 v10, s[8:11], s38 offen sc1 lds
    s_add_u32 m0, s42, 0x18c00
    s_nop 0
    buffer_load_dwordx4 v11, s[8:11], s38 offen sc1 lds
    s_mov_b32 s38, 0x280
    s_mov_b32 s39, 0xa0000
    s_add_u32 m0, s42, 0x1e000
    s_nop 0
    buffer_load_dwordx4 v8, s[8:11], s38 offen sc1 lds
    s_add_u32 m0, s42, 0x1e400
    s_nop 0
    buffer_load_dwordx4 v9, s[8:11], s38 offen sc1 lds
    s_add_u32 m0, s42, 0x1e800
    s_nop 0
    buffer_load_dwordx4 v10, s[8:11], s38 offen sc1 lds
    s_add_u32 m0, s42, 0x1ec00
    s_nop 0
    buffer_load_dwordx4 v11, s[8:11], s38 offen sc1 lds
    s_waitcnt vmcnt(12)
    s_barrier
    s_mov_b32 s38, 0x300
    s_mov_b32 s39, 0xc0000
    s_add_u32 m0, s42, 0x0
    s_nop 0
    buffer_load_dwordx4 v8, s[8:11], s38 offen sc1 lds
    s_add_u32 m0, s42, 0x400
    s_nop 0
    buffer_load_dwordx4 v9, s[8:11], s38 offen sc1 lds
    s_add_u32 m0, s42, 0x800
    s_nop 0
    buffer_load_dwordx4 v10, s[8:11], s38 offen sc1 lds
    s_add_u32 m0, s42, 0xc00
    s_nop 0
    buffer_load_dwordx4 v11, s[8:11], s38 offen sc1 lds
    s_add_u32 m0, s43, 0x0
    s_nop 0
    buffer_load_dwordx4 v12, s[12:15], s39 offen lds
    s_add_u32 m0, s43, 0x400
    s_nop 0
    buffer_load_dwordx4 v13, s[12:15], s39 offen lds
    s_mov_b32 s38, 0x380
    s_mov_b32 s39, 0xe0000
    s_add_u32 m0, s42, 0x6000
    s_nop 0
    buffer_load_dwordx4 v8, s[8:11], s38 offen sc1 lds
    s_add_u32 m0, s42, 0x6400
    s_nop 0
    buffer_load_dwordx4 v9, s[8:11], s38 offen sc1 lds
    s_add_u32 m0, s42, 0x6800
    s_nop 0
    buffer_load_dwordx4 v10, s[8:11], s38 offen sc1 lds
    s_add_u32 m0, s42, 0x6c00
    s_nop 0
    buffer_load_dwordx4 v11, s[8:11], s38 offen sc1 lds
    s_add_u32 m0, s43, 0x6000
    s_nop 0
    buffer_load_dwordx4 v12, s[12:15], s39 offen lds
    s_add_u32 m0, s43, 0x6400
    s_nop 0
    buffer_load_dwordx4 v13, s[12:15], s39 offen lds
    s_waitcnt vmcnt(20)
    s_barrier
    v_add_u32 v8, 0xffffe680, v8
    v_add_u32 v9, 0xffffe680, v9
    v_add_u32 v10, 0xffffe680, v10
    v_add_u32 v11, 0xffffe680, v11
    s_mov_b32 s38, 0x400
    s_mov_b32 s39, 0x100000
    s_add_u32 m0, s42, 0xc000
    s_nop 0
    buffer_load_dwordx4 v8, s[8:11], s38 offen sc1 lds
    s_add_u32 m0, s42, 0xc400
    s_nop 0
    buffer_load_dwordx4 v9, s[8:11], s38 offen sc1 lds
    s_add_u32 m0, s42, 0xc800
    s_nop 0
    buffer_load_dwordx4 v10, s[8:11], s38 offen sc1 lds
    s_add_u32 m0, s42, 0xcc00
    s_nop 0
    buffer_load_dwordx4 v11, s[8:11], s38 offen sc1 lds
    s_add_u32 m0, s43, 0xc000
    s_nop 0
    buffer_load_dwordx4 v12, s[12:15], s39 offen lds
    s_add_u32 m0, s43, 0xc400
    s_nop 0
    buffer_load_dwordx4 v13, s[12:15], s39 offen lds
    s_waitcnt vmcnt(22)
    s_barrier
    s_mov_b32 s38, 0x480
    s_mov_b32 s39, 0x120000
    s_add_u32 m0, s42, 0x12000
    s_nop 0
    buffer_load_dwordx4 v8, s[8:11], s38 offen sc1 lds
    s_add_u32 m0, s42, 0x12400
    s_nop 0
    buffer_load_dwordx4 v9, s[8:11], s38 offen sc1 lds
    s_add_u32 m0, s42, 0x12800
    s_nop 0
    buffer_load_dwordx4 v10, s[8:11], s38 offen sc1 lds
    s_add_u32 m0, s42, 0x12c00
    s_nop 0
    buffer_load_dwordx4 v11, s[8:11], s38 offen sc1 lds
    s_add_u32 m0, s43, 0x12000
    s_nop 0
    buffer_load_dwordx4 v12, s[12:15], s39 offen lds
    s_add_u32 m0, s43, 0x12400
    s_nop 0
    buffer_load_dwordx4 v13, s[12:15], s39 offen lds
    s_waitcnt vmcnt(24)
    s_barrier
    s_mov_b32 s38, 0x500
    s_mov_b32 s39, 0x140000
    s_add_u32 m0, s42, 0x18000
    s_nop 0
    buffer_load_dwordx4 v8, s[8:11], s38 offen sc1 lds
    s_add_u32 m0, s42, 0x18400
    s_nop 0
    buffer_load_dwordx4 v9, s[8:11], s38 offen sc1 lds
    s_add_u32 m0, s42, 0x18800
    s_nop 0
    buffer_load_dwordx4 v10, s[8:11], s38 offen sc1 lds
    s_add_u32 m0, s42, 0x18c00
    s_nop 0
    buffer_load_dwordx4 v11, s[8:11], s38 offen sc1 lds
    s_add_u32 m0, s43, 0x18000
    s_nop 0
    buffer_load_dwordx4 v12, s[12:15], s39 offen lds
    s_add_u32 m0, s43, 0x18400
    s_nop 0
    buffer_load_dwordx4 v13, s[12:15], s39 offen lds
    s_waitcnt vmcnt(24)
    s_barrier
    s_mov_b32 s38, 0x580
    s_mov_b32 s39, 0x160000
    s_add_u32 m0, s42, 0x1e000
    s_nop 0
    buffer_load_dwordx4 v8, s[8:11], s38 offen sc1 lds
    s_add_u32 m0, s42, 0x1e400
    s_nop 0
    buffer_load_dwordx4 v9, s[8:11], s38 offen sc1 lds
    s_add_u32 m0, s42, 0x1e800
    s_nop 0
    buffer_load_dwordx4 v10, s[8:11], s38 offen sc1 lds
    s_add_u32 m0, s42, 0x1ec00
    s_nop 0
    buffer_load_dwordx4 v11, s[8:11], s38 offen sc1 lds
    s_add_u32 m0, s43, 0x1e000
    s_nop 0
    buffer_load_dwordx4 v12, s[12:15], s39 offen lds
    s_add_u32 m0, s43, 0x1e400
    s_nop 0
    buffer_load_dwordx4 v13, s[12:15], s39 offen lds
    s_waitcnt vmcnt(24)
    s_barrier
    v_add_u32 v8, 0x2200, v8
    v_add_u32 v9, 0x2200, v9
    v_add_u32 v10, 0x2200, v10
    v_add_u32 v11, 0x2200, v11
    s_mov_b32 s38, 0x600
    s_mov_b32 s39, 0x180000
    s_add_u32 m0, s42, 0x0
    s_nop 0
    buffer_load_dwordx4 v8, s[8:11], s38 offen sc1 lds
    s_add_u32 m0, s42, 0x400
    s_nop 0
    buffer_load_dwordx4 v9, s[8:11], s38 offen sc1 lds
    s_add_u32 m0, s42, 0x800
    s_nop 0
    buffer_load_dwordx4 v10, s[8:11], s38 offen sc1 lds
    s_add_u32 m0, s42, 0xc00
    s_nop 0
    buffer_load_dwordx4 v11, s[8:11], s38 offen sc1 lds
    s_add_u32 m0, s43, 0x0
    s_nop 0
    buffer_load_dwordx4 v12, s[12:15], s39 offen lds
    s_add_u32 m0, s43, 0x400
    s_nop 0
    buffer_load_dwordx4 v13, s[12:15], s39 offen lds
    s_waitcnt vmcnt(24)
    s_barrier
    s_mov_b32 s38, 0x680
    s_mov_b32 s39, 0x1a0000
    s_add_u32 m0, s42, 0x6000
    s_nop 0
    buffer_load_dwordx4 v8, s[8:11], s38 offen sc1 lds
    s_add_u32 m0, s42, 0x6400
    s_nop 0
    buffer_load_dwordx4 v9, s[8:11], s38 offen sc1 lds
    s_add_u32 m0, s42, 0x6800
    s_nop 0
    buffer_load_dwordx4 v10, s[8:11], s38 offen sc1 lds
    s_add_u32 m0, s42, 0x6c00
    s_nop 0
    buffer_load_dwordx4 v11, s[8:11], s38 offen sc1 lds
    s_add_u32 m0, s43, 0x6000
    s_nop 0
    buffer_load_dwordx4 v12, s[12:15], s39 offen lds
    s_add_u32 m0, s43, 0x6400
    s_nop 0
    buffer_load_dwordx4 v13, s[12:15], s39 offen lds
    s_waitcnt vmcnt(24)
    s_barrier
    s_mov_b32 s38, 0x700
    s_mov_b32 s39, 0x1c0000
    s_add_u32 m0, s42, 0xc000
    s_nop 0
    buffer_load_dwordx4 v8, s[8:11], s38 offen sc1 lds
    s_add_u32 m0, s42, 0xc400
    s_nop 0
    buffer_load_dwordx4 v9, s[8:11], s38 offen sc1 lds
    s_add_u32 m0, s42, 0xc800
    s_nop 0
    buffer_load_dwordx4 v10, s[8:11], s38 offen sc1 lds
    s_add_u32 m0, s42, 0xcc00
    s_nop 0
    buffer_load_dwordx4 v11, s[8:11], s38 offen sc1 lds
    s_add_u32 m0, s43, 0xc000
    s_nop 0
    buffer_load_dwordx4 v12, s[12:15], s39 offen lds
    s_add_u32 m0, s43, 0xc400
    s_nop 0
    buffer_load_dwordx4 v13, s[12:15], s39 offen lds
    s_waitcnt vmcnt(24)
    s_barrier
    s_mov_b32 s38, 0x780
    s_mov_b32 s39, 0x1e0000
    s_add_u32 m0, s42, 0x12000
    s_nop 0
    buffer_load_dwordx4 v8, s[8:11], s38 offen sc1 lds
    s_add_u32 m0, s42, 0x12400
    s_nop 0
    buffer_load_dwordx4 v9, s[8:11], s38 offen sc1 lds
    s_add_u32 m0, s42, 0x12800
    s_nop 0
    buffer_load_dwordx4 v10, s[8:11], s38 offen sc1 lds
    s_add_u32 m0, s42, 0x12c00
    s_nop 0
    buffer_load_dwordx4 v11, s[8:11], s38 offen sc1 lds
    s_add_u32 m0, s43, 0x12000
    s_nop 0
    buffer_load_dwordx4 v12, s[12:15], s39 offen lds
    s_add_u32 m0, s43, 0x12400
    s_nop 0
    buffer_load_dwordx4 v13, s[12:15], s39 offen lds
    s_lshl_b32 s44, s32, 7
    s_add_u32 s44, s44, 0
    v_add_u32 v5, s44, v2
    v_lshrrev_b32 v3, 3, v5
    v_and_b32 v4, 7, v5
    v_add_u32 v3, s33, v3
    v_lshlrev_b32 v4, 4, v4
    s_lshl_b32 s45, s34, 1
    v_add_u32 v4, s45, v4
    v_mul_u32_u24 v5, 2176, v3
    v_add_u32 v248, v5, v4
    v_mul_u32_u24 v5, 2048, v3
    v_add_u32 v252, v5, v4
    buffer_load_dwordx4 v[240:243], v252, s[16:19], 0 offen
    s_lshl_b32 s44, s32, 7
    s_add_u32 s44, s44, 64
    v_add_u32 v5, s44, v2
    v_lshrrev_b32 v3, 3, v5
    v_and_b32 v4, 7, v5
    v_add_u32 v3, s33, v3
    v_lshlrev_b32 v4, 4, v4
    s_lshl_b32 s45, s34, 1
    v_add_u32 v4, s45, v4
    v_mul_u32_u24 v5, 2176, v3
    v_add_u32 v249, v5, v4
    v_mul_u32_u24 v5, 2048, v3
    v_add_u32 v253, v5, v4
    buffer_load_dwordx4 v[244:247], v253, s[16:19], 0 offen
    s_mov_b32 s72, s62
    s_mov_b32 s73, s63
    s_mov_b32 s74, 0x700000
    s_mov_b32 s75, 0x20000
    s_lshl_b32 s44, s49, 6
    s_lshl_b32 s45, s35, 4
    s_add_u32 s44, s44, s45
    v_lshrrev_b32 v3, 5, v2
    v_add_u32 v3, s44, v3
    v_mul_u32_u24 v3, 7168, v3
    v_and_b32 v4, 31, v2
    v_lshl_add_u32 v3, v4, 4, v3
    s_mul_i32 s45, s48, 448
    v_add_u32 v3, s45, v3
    v_cmp_gt_u32 vcc, 28, v4
    v_mov_b32 v5, 0x7ffffff0
    s_nop 0
    v_cndmask_b32 v3, v5, v3, vcc
    s_mov_b32 s44, 0x0
    buffer_load_dwordx4 v[64:67], v3, s[72:75], s44 offen
    s_mov_b32 s44, 0x3800
    buffer_load_dwordx4 v[68:71], v3, s[72:75], s44 offen
    s_mov_b32 s44, 0x7000
    buffer_load_dwordx4 v[72:75], v3, s[72:75], s44 offen
    s_mov_b32 s44, 0xa800
    buffer_load_dwordx4 v[76:79], v3, s[72:75], s44 offen
    s_mov_b32 s44, 0xe000
    buffer_load_dwordx4 v[80:83], v3, s[72:75], s44 offen
    s_mov_b32 s44, 0x11800
    buffer_load_dwordx4 v[84:87], v3, s[72:75], s44 offen
    s_mov_b32 s44, 0x15000
    buffer_load_dwordx4 v[88:91], v3, s[72:75], s44 offen
    s_mov_b32 s44, 0x18800
    buffer_load_dwordx4 v[92:95], v3, s[72:75], s44 offen
    s_waitcnt vmcnt(34)
    s_barrier
    s_waitcnt vmcnt(28)
    s_barrier
    s_waitcnt vmcnt(22)
    s_barrier
    s_waitcnt vmcnt(16)
    s_barrier
    s_waitcnt vmcnt(10)
    s_barrier
    s_barrier
    s_waitcnt vmcnt(0)
    v_mov_b32 v112, 0
    v_mov_b32 v113, 0
    v_mov_b32 v114, 0
    v_mov_b32 v115, 0
    v_mov_b32 v116, 0
    v_mov_b32 v117, 0
    v_mov_b32 v118, 0
    v_mov_b32 v119, 0
    v_lshlrev_b32 v22, 16, v64
    v_and_b32 v23, s52, v64
    v_add_f32 v112, v112, v22
    v_add_f32 v113, v113, v23
    v_lshlrev_b32 v22, 16, v65
    v_and_b32 v23, s52, v65
    v_add_f32 v114, v114, v22
    v_add_f32 v115, v115, v23
    v_lshlrev_b32 v22, 16, v66
    v_and_b32 v23, s52, v66
    v_add_f32 v116, v116, v22
    v_add_f32 v117, v117, v23
    v_lshlrev_b32 v22, 16, v67
    v_and_b32 v23, s52, v67
    v_add_f32 v118, v118, v22
    v_add_f32 v119, v119, v23
    v_lshlrev_b32 v22, 16, v68
    v_and_b32 v23, s52, v68
    v_add_f32 v112, v112, v22
    v_add_f32 v113, v113, v23
    v_lshlrev_b32 v22, 16, v69
    v_and_b32 v23, s52, v69
    v_add_f32 v114, v114, v22
    v_add_f32 v115, v115, v23
    v_lshlrev_b32 v22, 16, v70
    v_and_b32 v23, s52, v70
    v_add_f32 v116, v116, v22
    v_add_f32 v117, v117, v23
    v_lshlrev_b32 v22, 16, v71
    v_and_b32 v23, s52, v71
    v_add_f32 v118, v118, v22
    v_add_f32 v119, v119, v23
    v_lshlrev_b32 v22, 16, v72
    v_and_b32 v23, s52, v72
    v_add_f32 v112, v112, v22
    v_add_f32 v113, v113, v23
    v_lshlrev_b32 v22, 16, v73
    v_and_b32 v23, s52, v73
    v_add_f32 v114, v114, v22
    v_add_f32 v115, v115, v23
    v_lshlrev_b32 v22, 16, v74
    v_and_b32 v23, s52, v74
    v_add_f32 v116, v116, v22
    v_add_f32 v117, v117, v23
    v_lshlrev_b32 v22, 16, v75
    v_and_b32 v23, s52, v75
    v_add_f32 v118, v118, v22
    v_add_f32 v119, v119, v23
    v_lshlrev_b32 v22, 16, v76
    v_and_b32 v23, s52, v76
    v_add_f32 v112, v112, v22
    v_add_f32 v113, v113, v23
    v_lshlrev_b32 v22, 16, v77
    v_and_b32 v23, s52, v77
    v_add_f32 v114, v114, v22
    v_add_f32 v115, v115, v23
    v_lshlrev_b32 v22, 16, v78
    v_and_b32 v23, s52, v78
    v_add_f32 v116, v116, v22
    v_add_f32 v117, v117, v23
    v_lshlrev_b32 v22, 16, v79
    v_and_b32 v23, s52, v79
    v_add_f32 v118, v118, v22
    v_add_f32 v119, v119, v23
    v_lshlrev_b32 v22, 16, v80
    v_and_b32 v23, s52, v80
    v_add_f32 v112, v112, v22
    v_add_f32 v113, v113, v23
    v_lshlrev_b32 v22, 16, v81
    v_and_b32 v23, s52, v81
    v_add_f32 v114, v114, v22
    v_add_f32 v115, v115, v23
    v_lshlrev_b32 v22, 16, v82
    v_and_b32 v23, s52, v82
    v_add_f32 v116, v116, v22
    v_add_f32 v117, v117, v23
    v_lshlrev_b32 v22, 16, v83
    v_and_b32 v23, s52, v83
    v_add_f32 v118, v118, v22
    v_add_f32 v119, v119, v23
    v_lshlrev_b32 v22, 16, v84
    v_and_b32 v23, s52, v84
    v_add_f32 v112, v112, v22
    v_add_f32 v113, v113, v23
    v_lshlrev_b32 v22, 16, v85
    v_and_b32 v23, s52, v85
    v_add_f32 v114, v114, v22
    v_add_f32 v115, v115, v23
    v_lshlrev_b32 v22, 16, v86
    v_and_b32 v23, s52, v86
    v_add_f32 v116, v116, v22
    v_add_f32 v117, v117, v23
    v_lshlrev_b32 v22, 16, v87
    v_and_b32 v23, s52, v87
    v_add_f32 v118, v118, v22
    v_add_f32 v119, v119, v23
    v_lshlrev_b32 v22, 16, v88
    v_and_b32 v23, s52, v88
    v_add_f32 v112, v112, v22
    v_add_f32 v113, v113, v23
    v_lshlrev_b32 v22, 16, v89
    v_and_b32 v23, s52, v89
    v_add_f32 v114, v114, v22
    v_add_f32 v115, v115, v23
    v_lshlrev_b32 v22, 16, v90
    v_and_b32 v23, s52, v90
    v_add_f32 v116, v116, v22
    v_add_f32 v117, v117, v23
    v_lshlrev_b32 v22, 16, v91
    v_and_b32 v23, s52, v91
    v_add_f32 v118, v118, v22
    v_add_f32 v119, v119, v23
    v_lshlrev_b32 v22, 16, v92
    v_and_b32 v23, s52, v92
    v_add_f32 v112, v112, v22
    v_add_f32 v113, v113, v23
    v_lshlrev_b32 v22, 16, v93
    v_and_b32 v23, s52, v93
    v_add_f32 v114, v114, v22
    v_add_f32 v115, v115, v23
    v_lshlrev_b32 v22, 16, v94
    v_and_b32 v23, s52, v94
    v_add_f32 v116, v116, v22
    v_add_f32 v117, v117, v23
    v_lshlrev_b32 v22, 16, v95
    v_and_b32 v23, s52, v95
    v_add_f32 v118, v118, v22
    v_add_f32 v119, v119, v23
    v_lshrrev_b32 v3, 5, v2
    s_lshl_b32 s44, s35, 1
    v_add_u32 v3, s44, v3
    v_mul_u32_u24 v3, 1024, v3
    v_and_b32 v4, 31, v2
    v_lshl_add_u32 v3, v4, 5, v3
    ds_write_b128 v3, v[112:115] offset:49152
    ds_write_b128 v3, v[116:119] offset:49168
    s_waitcnt lgkmcnt(0)
k2_kernel_store:
    s_barrier
    v_and_b32 v2, 63, v0
    s_lshl_b32 s44, s32, 7
    s_add_u32 s44, s44, 0
    v_add_u32 v5, s44, v2
    v_lshrrev_b32 v3, 3, v5
    v_and_b32 v4, 7, v5
    v_mul_u32_u24 v6, 144, v3
    v_lshl_add_u32 v6, v4, 4, v6
    ds_read_b128 v[32:35], v6
    s_lshl_b32 s44, s32, 7
    s_add_u32 s44, s44, 64
    v_add_u32 v5, s44, v2
    v_lshrrev_b32 v3, 3, v5
    v_and_b32 v4, 7, v5
    v_mul_u32_u24 v6, 144, v3
    v_lshl_add_u32 v6, v4, 4, v6
    ds_read_b128 v[36:39], v6
    s_waitcnt vmcnt(0) lgkmcnt(0)
    v_lshlrev_b32 v8, 16, v32
    v_lshlrev_b32 v9, 16, v240
    v_and_b32 v10, s52, v32
    v_and_b32 v11, s52, v240
    v_add_f32 v8, v8, v9
    v_add_f32 v10, v10, v11
    v_cvt_pk_bf16_f32 v32, v8, v10
    v_lshlrev_b32 v8, 16, v33
    v_lshlrev_b32 v9, 16, v241
    v_and_b32 v10, s52, v33
    v_and_b32 v11, s52, v241
    v_add_f32 v8, v8, v9
    v_add_f32 v10, v10, v11
    v_cvt_pk_bf16_f32 v33, v8, v10
    v_lshlrev_b32 v8, 16, v34
    v_lshlrev_b32 v9, 16, v242
    v_and_b32 v10, s52, v34
    v_and_b32 v11, s52, v242
    v_add_f32 v8, v8, v9
    v_add_f32 v10, v10, v11
    v_cvt_pk_bf16_f32 v34, v8, v10
    v_lshlrev_b32 v8, 16, v35
    v_lshlrev_b32 v9, 16, v243
    v_and_b32 v10, s52, v35
    v_and_b32 v11, s52, v243
    v_add_f32 v8, v8, v9
    v_add_f32 v10, v10, v11
    v_cvt_pk_bf16_f32 v35, v8, v10
    buffer_store_dwordx4 v[32:35], v248, s[20:23], 0 offen sc1
    v_lshlrev_b32 v8, 16, v36
    v_lshlrev_b32 v9, 16, v244
    v_and_b32 v10, s52, v36
    v_and_b32 v11, s52, v244
    v_add_f32 v8, v8, v9
    v_add_f32 v10, v10, v11
    v_cvt_pk_bf16_f32 v36, v8, v10
    v_lshlrev_b32 v8, 16, v37
    v_lshlrev_b32 v9, 16, v245
    v_and_b32 v10, s52, v37
    v_and_b32 v11, s52, v245
    v_add_f32 v8, v8, v9
    v_add_f32 v10, v10, v11
    v_cvt_pk_bf16_f32 v37, v8, v10
    v_lshlrev_b32 v8, 16, v38
    v_lshlrev_b32 v9, 16, v246
    v_and_b32 v10, s52, v38
    v_and_b32 v11, s52, v246
    v_add_f32 v8, v8, v9
    v_add_f32 v10, v10, v11
    v_cvt_pk_bf16_f32 v38, v8, v10
    v_lshlrev_b32 v8, 16, v39
    v_lshlrev_b32 v9, 16, v247
    v_and_b32 v10, s52, v39
    v_and_b32 v11, s52, v247
    v_add_f32 v8, v8, v9
    v_add_f32 v10, v10, v11
    v_cvt_pk_bf16_f32 v39, v8, v10
    buffer_store_dwordx4 v[36:39], v249, s[20:23], 0 offen sc1
    v_mov_b32 v21, 0x3f803f80
    v_mov_b32 v12, 0
    v_mov_b32 v13, 0
    v_dot2c_f32_bf16 v12, v32, v21
    v_dot2c_f32_bf16 v13, v32, v32
    v_dot2c_f32_bf16 v12, v33, v21
    v_dot2c_f32_bf16 v13, v33, v33
    v_dot2c_f32_bf16 v12, v34, v21
    v_dot2c_f32_bf16 v13, v34, v34
    v_dot2c_f32_bf16 v12, v35, v21
    v_dot2c_f32_bf16 v13, v35, v35
    v_mov_b32 v14, 0
    v_mov_b32 v15, 0
    v_dot2c_f32_bf16 v14, v36, v21
    v_dot2c_f32_bf16 v15, v36, v36
    v_dot2c_f32_bf16 v14, v37, v21
    v_dot2c_f32_bf16 v15, v37, v37
    v_dot2c_f32_bf16 v14, v38, v21
    v_dot2c_f32_bf16 v15, v38, v38
    v_dot2c_f32_bf16 v14, v39, v21
    v_dot2c_f32_bf16 v15, v39, v39
    s_nop 3
    v_add_f32_dpp v12, v12, v12 quad_perm:[1,0,3,2] row_mask:0xf bank_mask:0xf
    v_add_f32_dpp v13, v13, v13 quad_perm:[1,0,3,2] row_mask:0xf bank_mask:0xf
    v_add_f32_dpp v14, v14, v14 quad_perm:[1,0,3,2] row_mask:0xf bank_mask:0xf
    v_add_f32_dpp v15, v15, v15 quad_perm:[1,0,3,2] row_mask:0xf bank_mask:0xf
    s_nop 0
    v_add_f32_dpp v12, v12, v12 quad_perm:[2,3,0,1] row_mask:0xf bank_mask:0xf
    v_add_f32_dpp v13, v13, v13 quad_perm:[2,3,0,1] row_mask:0xf bank_mask:0xf
    v_add_f32_dpp v14, v14, v14 quad_perm:[2,3,0,1] row_mask:0xf bank_mask:0xf
    v_add_f32_dpp v15, v15, v15 quad_perm:[2,3,0,1] row_mask:0xf bank_mask:0xf
    s_nop 0
    v_add_f32_dpp v12, v12, v12 row_half_mirror row_mask:0xf bank_mask:0xf
    v_add_f32_dpp v13, v13, v13 row_half_mirror row_mask:0xf bank_mask:0xf
    v_add_f32_dpp v14, v14, v14 row_half_mirror row_mask:0xf bank_mask:0xf
    v_add_f32_dpp v15, v15, v15 row_half_mirror row_mask:0xf bank_mask:0xf
    s_nop 0
    s_lshl_b32 s44, s32, 7
    s_add_u32 s44, s44, 0
    v_add_u32 v5, s44, v2
    v_lshrrev_b32 v3, 3, v5
    v_and_b32 v4, 7, v5
    v_add_u32 v3, s33, v3
    v_lshlrev_b32 v3, 3, v3
    s_lshl_b32 s45, s49, 14
    v_add_u32 v3, s45, v3
    v_cmp_eq_u32 vcc, 0, v4
    v_mov_b32 v5, 0x7ffffff0
    s_nop 0
    v_cndmask_b32 v3, v5, v3, vcc
    buffer_store_dwordx2 v[12:13], v3, s[24:27], 0 offen sc1
    s_lshl_b32 s44, s32, 7
    s_add_u32 s44, s44, 64
    v_add_u32 v5, s44, v2
    v_lshrrev_b32 v3, 3, v5
    v_and_b32 v4, 7, v5
    v_add_u32 v3, s33, v3
    v_lshlrev_b32 v3, 3, v3
    s_lshl_b32 s45, s49, 14
    v_add_u32 v3, s45, v3
    v_cmp_eq_u32 vcc, 0, v4
    v_mov_b32 v5, 0x7ffffff0
    s_nop 0
    v_cndmask_b32 v3, v5, v3, vcc
    buffer_store_dwordx2 v[14:15], v3, s[24:27], 0 offen sc1
    s_cmp_lt_u32 s32, 4
    s_cbranch_scc1 k2_kernel_fin
    v_subrev_u32 v3, 256, v0
    v_lshlrev_b32 v4, 2, v3
    ds_read_b32 v40, v4 offset:49152
    ds_read_b32 v41, v4 offset:50176
    ds_read_b32 v42, v4 offset:51200
    ds_read_b32 v43, v4 offset:52224
    ds_read_b32 v44, v4 offset:53248
    ds_read_b32 v45, v4 offset:54272
    ds_read_b32 v46, v4 offset:55296
    ds_read_b32 v47, v4 offset:56320
    s_waitcnt lgkmcnt(0)
    v_add_f32 v40, v40, v41
    v_add_f32 v40, v40, v42
    v_add_f32 v40, v40, v43
    v_add_f32 v40, v40, v44
    v_add_f32 v40, v40, v45
    v_add_f32 v40, v40, v46
    v_add_f32 v40, v40, v47
    s_mov_b32 s44, s49
    s_mul_i32 s44, s44, 14336
    s_mov_b32 s45, s48
    s_mul_i32 s45, s45, 896
    s_add_u32 s44, s44, s45
    v_add_u32 v4, s44, v4
    v_cmp_gt_u32 vcc, 224, v3
    v_mov_b32 v5, 0x7ffffff0
    s_nop 0
    v_cndmask_b32 v4, v5, v4, vcc
    buffer_store_dword v40, v4, s[28:31], 0 offen sc1
k2_kernel_fin:
    s_waitcnt vmcnt(0) lgkmcnt(0)
k2_kernel_finnw:
k2_kernel_pskip:
    s_barrier
    s_cmp_lg_u32 s32, 4
    s_cbranch_scc1 k3_kernel
    s_add_u32 s24, s70, 0x1b20800
    s_addc_u32 s25, s71, 0
    s_mov_b32 s26, 0x800
    s_mov_b32 s27, 0x20000
    s_lshl_b32 s44, s48, 4
    s_add_u32 s44, s44, s49
    s_lshl_b32 s44, s44, 3
    v_and_b32 v2, 63, v0
    v_mov_b32 v22, s44
    v_mov_b32 v23, 0x7ffffff0
    v_cmp_eq_u32 vcc, 0, v2
    v_mov_b32 v24, s6
    v_mov_b32 v25, s7
    v_cndmask_b32 v22, v23, v22, vcc
    buffer_store_dwordx2 v[24:25], v22, s[24:27], 0 offen sc1
    s_branch k3_kernel
k2_kernel_cons:
    s_lshr_b32 s36, s32, 1
    s_and_b32 s37, s32, 1
    v_and_b32 v3, 15, v2
    v_lshrrev_b32 v4, 4, v2
    s_lshl_b32 s44, s36, 13
    v_lshlrev_b32 v5, 7, v3
    v_lshrrev_b32 v6, 1, v3
    v_xor_b32 v6, v6, v4
    v_lshlrev_b32 v6, 4, v6
    v_add3_u32 v8, v5, v6, s44
    v_xor_b32 v9, 64, v8
    v_lshrrev_b32 v5, 2, v3
    v_lshl_add_u32 v6, v4, 3, v5
    v_and_b32 v7, 3, v2
    v_lshlrev_b32 v6, 7, v6
    v_lshl_add_u32 v6, v7, 3, v6
    v_lshrrev_b32 v5, 1, v5
    v_and_b32 v7, 1, v4
    v_lshl_or_b32 v5, v7, 1, v5
    s_lshl_b32 s44, s37, 1
    v_xor_b32 v5, s44, v5
    v_lshl_add_u32 v6, v5, 5, v6
    v_add_u32 v12, 16384, v6
    v_xor_b32 v13, 32, v12
    v_mov_b32 v128, 0
    v_mov_b32 v129, 0
    v_mov_b32 v130, 0
    v_mov_b32 v131, 0
    v_mov_b32 v132, 0
    v_mov_b32 v133, 0
    v_mov_b32 v134, 0
    v_mov_b32 v135, 0
    v_mov_b32 v136, 0
    v_mov_b32 v137, 0
    v_mov_b32 v138, 0
    v_mov_b32 v139, 0
    v_mov_b32 v140, 0
    v_mov_b32 v141, 0
    v_mov_b32 v142, 0
    v_mov_b32 v143, 0
    v_mov_b32 v144, 0
    v_mov_b32 v145, 0
    v_mov_b32 v146, 0
    v_mov_b32 v147, 0
    v_mov_b32 v148, 0
    v_mov_b32 v149, 0
    v_mov_b32 v150, 0
    v_mov_b32 v151, 0
    v_mov_b32 v152, 0
    v_mov_b32 v153, 0
    v_mov_b32 v154, 0
    v_mov_b32 v155, 0
    v_mov_b32 v156, 0
    v_mov_b32 v157, 0
    v_mov_b32 v158, 0
    v_mov_b32 v159, 0
    s_add_u32 s20, s70, 0x500000
    s_addc_u32 s21, s71, 0
    s_mov_b32 s22, 0x440000
    s_mov_b32 s23, 0x20000
    s_mov_b32 s16, s56
    s_mov_b32 s17, s57
    s_mov_b32 s18, 0x400000
    s_mov_b32 s19, 0x20000
    s_add_u32 s24, s70, 0x1a00000
    s_addc_u32 s25, s71, 0
    s_mov_b32 s26, 0x40000
    s_mov_b32 s27, 0x20000
    s_add_u32 s28, s70, 0x1a40000
    s_addc_u32 s29, s71, 0
    s_mov_b32 s30, 0x38000
    s_mov_b32 s31, 0x20000
    s_lshl_b32 s44, s32, 7
    s_add_u32 s44, s44, 0
    v_add_u32 v5, s44, v2
    v_lshrrev_b32 v3, 3, v5
    v_and_b32 v4, 7, v5
    v_add_u32 v3, s33, v3
    v_lshlrev_b32 v4, 4, v4
    s_lshl_b32 s45, s34, 1
    v_add_u32 v4, s45, v4
    v_mul_u32_u24 v5, 2176, v3
    v_add_u32 v248, v5, v4
    v_mul_u32_u24 v5, 2048, v3
    v_add_u32 v252, v5, v4
    buffer_load_dwordx4 v[240:243], v252, s[16:19], 0 offen
    s_lshl_b32 s44, s32, 7
    s_add_u32 s44, s44, 64
    v_add_u32 v5, s44, v2
    v_lshrrev_b32 v3, 3, v5
    v_and_b32 v4, 7, v5
    v_add_u32 v3, s33, v3
    v_lshlrev_b32 v4, 4, v4
    s_lshl_b32 s45, s34, 1
    v_add_u32 v4, s45, v4
    v_mul_u32_u24 v5, 2176, v3
    v_add_u32 v249, v5, v4
    v_mul_u32_u24 v5, 2048, v3
    v_add_u32 v253, v5, v4
    buffer_load_dwordx4 v[244:247], v253, s[16:19], 0 offen
    s_mov_b32 s41, 0
    s_mov_b32 s40, 16
    s_barrier
    s_barrier
    v_add_u32 v10, s41, v8
    v_add_u32 v11, s41, v9
    v_add_u32 v16, s41, v12
    v_add_u32 v17, s41, v13
    ds_read_b128 v[32:35], v10 offset:0
    ds_read_b64_tr_b16 v[48:49], v16 offset:0
    ds_read_b64_tr_b16 v[50:51], v16 offset:512
    ds_read_b128 v[36:39], v10 offset:2048
    ds_read_b128 v[40:43], v10 offset:4096
    ds_read_b128 v[44:47], v10 offset:6144
    ds_read_b64_tr_b16 v[52:53], v17 offset:0
    ds_read_b64_tr_b16 v[54:55], v17 offset:512
k2_kernel_loop:
    s_cmp_eq_u32 s40, 10
    s_cbranch_scc1 k2_kernel_pfat0
k2_kernel_pfat0_r:
    s_waitcnt lgkmcnt(0)
    v_mfma_f32_16x16x32_bf16 v[128:131], v[48:51], v[32:35], v[128:131]
    ds_read_b128 v[56:59], v11 offset:0
    v_mfma_f32_16x16x32_bf16 v[136:139], v[48:51], v[36:39], v[136:139]
    ds_read_b64_tr_b16 v[72:73], v16 offset:4096
    v_mfma_f32_16x16x32_bf16 v[144:147], v[48:51], v[40:43], v[144:147]
    ds_read_b64_tr_b16 v[74:75], v16 offset:4608
    v_mfma_f32_16x16x32_bf16 v[152:155], v[48:51], v[44:47], v[152:155]
    ds_read_b128 v[60:63], v11 offset:2048
    v_mfma_f32_16x16x32_bf16 v[132:135], v[52:55], v[32:35], v[132:135]
    ds_read_b128 v[64:67], v11 offset:4096
    v_mfma_f32_16x16x32_bf16 v[140:143], v[52:55], v[36:39], v[140:143]
    ds_read_b128 v[68:71], v11 offset:6144
    v_mfma_f32_16x16x32_bf16 v[148:151], v[52:55], v[40:43], v[148:151]
    ds_read_b64_tr_b16 v[76:77], v17 offset:4096
    v_mfma_f32_16x16x32_bf16 v[156:159], v[52:55], v[44:47], v[156:159]
    ds_read_b64_tr_b16 v[78:79], v17 offset:4608
    s_add_u32 s41, s41, 24576
    s_cmp_eq_u32 s41, 147456
    s_cselect_b32 s41, 0, s41
    v_add_u32 v10, s41, v8
    v_add_u32 v16, s41, v12
    v_add_u32 v17, s41, v13
    s_waitcnt lgkmcnt(0)
    s_barrier
    v_mfma_f32_16x16x32_bf16 v[128:131], v[72:75], v[56:59], v[128:131]
    ds_read_b128 v[32:35], v10 offset:0
    v_mfma_f32_16x16x32_bf16 v[136:139], v[72:75], v[60:63], v[136:139]
    ds_read_b64_tr_b16 v[48:49], v16 offset:0
    v_mfma_f32_16x16x32_bf16 v[144:147], v[72:75], v[64:67], v[144:147]
    ds_read_b64_tr_b16 v[50:51], v16 offset:512
    v_mfma_f32_16x16x32_bf16 v[152:155], v[72:75], v[68:71], v[152:155]
    ds_read_b128 v[36:39], v10 offset:2048
    v_mfma_f32_16x16x32_bf16 v[132:135], v[76:79], v[56:59], v[132:135]
    ds_read_b128 v[40:43], v10 offset:4096
    v_mfma_f32_16x16x32_bf16 v[140:143], v[76:79], v[60:63], v[140:143]
    ds_read_b128 v[44:47], v10 offset:6144
    v_mfma_f32_16x16x32_bf16 v[148:151], v[76:79], v[64:67], v[148:151]
    ds_read_b64_tr_b16 v[52:53], v17 offset:0
    v_mfma_f32_16x16x32_bf16 v[156:159], v[76:79], v[68:71], v[156:159]
    ds_read_b64_tr_b16 v[54:55], v17 offset:512
    v_add_u32 v11, s41, v9
    s_sub_u32 s40, s40, 1
    s_cmp_lg_u32 s40, 0
    s_cbranch_scc1 k2_kernel_loop
    s_branch k2_kernel_after
k2_kernel_pfat0:
    s_cmp_lg_u32 s32, 3
    s_cbranch_scc1 k2_kernel_pfat0_r
    s_getpc_b64 s[4:5]
k2_kernel_cpf1:
    s_add_u32 s4, s4, k3_kernel-k2_kernel_cpf1
    s_addc_u32 s5, s5, 0
    s_and_b32 s44, s54, 1
    s_lshl_b32 s44, s44, 13
    v_lshlrev_b32 v6, 7, v2
    v_add_u32 v6, s44, v6
    v_min_u32 v6, k3_kernel_end-k3_kernel-4, v6
    global_load_dword v250, v6, s[4:5]
    s_branch k2_kernel_pfat0_r
k2_kernel_after:
    s_waitcnt lgkmcnt(0)
    s_nop 7
    s_nop 7
    v_and_b32 v3, 15, v2
    v_lshrrev_b32 v4, 4, v2
    s_mul_i32 s44, s36, 9216
    s_mul_i32 s45, s37, 64
    s_add_u32 s44, s44, s45
    v_mul_u32_u24 v5, 144, v3
    v_lshl_add_u32 v5, v4, 3, v5
    v_add_u32 v5, s44, v5
    v_cvt_pk_bf16_f32 v128, v128, v129
    v_cvt_pk_bf16_f32 v129, v130, v131
    v_cvt_pk_bf16_f32 v132, v132, v133
    v_cvt_pk_bf16_f32 v133, v134, v135
    ds_write_b64 v5, v[128:129] offset:0
    ds_write_b64 v5, v[132:133] offset:32
    v_cvt_pk_bf16_f32 v136, v136, v137
    v_cvt_pk_bf16_f32 v137, v138, v139
    v_cvt_pk_bf16_f32 v140, v140, v141
    v_cvt_pk_bf16_f32 v141, v142, v143
    ds_write_b64 v5, v[136:137] offset:2304
    ds_write_b64 v5, v[140:141] offset:2336
    v_cvt_pk_bf16_f32 v144, v144, v145
    v_cvt_pk_bf16_f32 v145, v146, v147
    v_cvt_pk_bf16_f32 v148, v148, v149
    v_cvt_pk_bf16_f32 v149, v150, v151
    ds_write_b64 v5, v[144:145] offset:4608
    ds_write_b64 v5, v[148:149] offset:4640
    v_cvt_pk_bf16_f32 v152, v152, v153
    v_cvt_pk_bf16_f32 v153, v154, v155
    v_cvt_pk_bf16_f32 v156, v156, v157
    v_cvt_pk_bf16_f32 v157, v158, v159
    ds_write_b64 v5, v[152:153] offset:6912
    ds_write_b64 v5, v[156:157] offset:6944
    s_waitcnt lgkmcnt(0)
    s_branch k2_kernel_store
k2_kernel_end:
k3_kernel:
    s_and_b32 s53, s2, 7
    s_lshr_b32 s54, s2, 3
    s_lshr_b32 s45, s53, 2
    s_and_b32 s45, s45, 1
    s_lshl_b32 s45, s45, 3
    s_lshr_b32 s46, s54, 2
    s_and_b32 s46, s46, 7
    s_add_u32 s48, s45, s46
    s_lshr_b32 s45, s53, 0
    s_and_b32 s45, s45, 3
    s_lshl_b32 s45, s45, 2
    s_lshr_b32 s46, s54, 0
    s_and_b32 s46, s46, 3
    s_add_u32 s49, s45, s46
    s_lshl_b32 s33, s48, 7
    s_mul_i32 s34, s49, 224
    v_lshrrev_b32 v1, 6, v0
    v_and_b32 v2, 63, v0
    s_nop 0
    v_readfirstlane_b32 s32, v1
    s_mov_b32 s50, 0xc0135761
    s_mov_b32 s51, 0xbdd2d3e8
    s_mov_b32 s52, 0xffff0000
    s_waitcnt lgkmcnt(0)
    s_add_u32 s8, s70, 0x500000
    s_addc_u32 s9, s71, 0
    s_mov_b32 s10, 0x440000
    s_mov_b32 s11, 0x20000
    s_mov_b32 s12, s62
    s_mov_b32 s13, s63
    s_mov_b32 s14, 0x700000
    s_mov_b32 s15, 0x20000
    s_cmp_lt_u32 s32, 4
    s_cbranch_scc1 k3_kernel_cons
k3_kernel_prod:
    s_sub_u32 s35, s32, 4
    v_lshrrev_b32 v3, 3, v2
    v_and_b32 v4, 7, v2
    v_lshrrev_b32 v5, 4, v2
    s_lshl_b32 s44, s35, 5
    s_add_u32 s44, s44, s33
    s_mov_b32 s45, 2176
    v_add_u32 v6, s44, v3
    v_mul_lo_u32 v6, v6, s45
    v_xor_b32 v7, v4, v5
    v_lshl_add_u32 v8, v7, 4, v6
    v_xor_b32 v7, 4, v7
    v_lshl_add_u32 v9, v7, 4, v6
    v_add_u32 v9, 17408, v9
    v_add_u32 v10, 34816, v8
    v_add_u32 v11, 34816, v9
    s_lshl_b32 s46, s34, 1
    s_mov_b32 s45, 7168
    s_mul_i32 s44, s35, 448
    s_add_u32 s44, s44, 0
    v_add_u32 v6, s44, v2
    v_mul_u32_u24 v7, 2341, v6
    v_lshrrev_b32 v7, 16, v7
    v_mul_u32_u24 v20, 28, v7
    v_sub_u32 v6, v6, v20
    v_bfe_u32 v20, v7, 3, 1
    v_lshlrev_b32 v20, 1, v20
    v_xor_b32 v6, v6, v20
    v_mul_lo_u32 v7, v7, s45
    v_lshl_add_u32 v6, v6, 4, v7
    v_add_u32 v12, s46, v6
    s_mul_i32 s44, s35, 448
    s_add_u32 s44, s44, 64
    v_add_u32 v6, s44, v2
    v_mul_u32_u24 v7, 2341, v6
    v_lshrrev_b32 v7, 16, v7
    v_mul_u32_u24 v20, 28, v7
    v_sub_u32 v6, v6, v20
    v_bfe_u32 v20, v7, 3, 1
    v_lshlrev_b32 v20, 1, v20
    v_xor_b32 v6, v6, v20
    v_mul_lo_u32 v7, v7, s45
    v_lshl_add_u32 v6, v6, 4, v7
    v_add_u32 v13, s46, v6
    s_mul_i32 s44, s35, 448
    s_add_u32 s44, s44, 128
    v_add_u32 v6, s44, v2
    v_mul_u32_u24 v7, 2341, v6
    v_lshrrev_b32 v7, 16, v7
    v_mul_u32_u24 v20, 28, v7
    v_sub_u32 v6, v6, v20
    v_bfe_u32 v20, v7, 3, 1
    v_lshlrev_b32 v20, 1, v20
    v_xor_b32 v6, v6, v20
    v_mul_lo_u32 v7, v7, s45
    v_lshl_add_u32 v6, v6, 4, v7
    v_add_u32 v14, s46, v6
    s_mul_i32 s44, s35, 448
    s_add_u32 s44, s44, 192
    v_add_u32 v6, s44, v2
    v_mul_u32_u24 v7, 2341, v6
    v_lshrrev_b32 v7, 16, v7
    v_mul_u32_u24 v20, 28, v7
    v_sub_u32 v6, v6, v20
    v_bfe_u32 v20, v7, 3, 1
    v_lshlrev_b32 v20, 1, v20
    v_xor_b32 v6, v6, v20
    v_mul_lo_u32 v7, v7, s45
    v_lshl_add_u32 v6, v6, 4, v7
    v_add_u32 v15, s46, v6
    s_mul_i32 s44, s35, 448
    s_add_u32 s44, s44, 256
    v_add_u32 v6, s44, v2
    v_mul_u32_u24 v7, 2341, v6
    v_lshrrev_b32 v7, 16, v7
    v_mul_u32_u24 v20, 28, v7
    v_sub_u32 v6, v6, v20
    v_bfe_u32 v20, v7, 3, 1
    v_lshlrev_b32 v20, 1, v20
    v_xor_b32 v6, v6, v20
    v_mul_lo_u32 v7, v7, s45
    v_lshl_add_u32 v6, v6, 4, v7
    v_add_u32 v16, s46, v6
    s_mul_i32 s44, s35, 448
    s_add_u32 s44, s44, 320
    v_add_u32 v6, s44, v2
    v_mul_u32_u24 v7, 2341, v6
    v_lshrrev_b32 v7, 16, v7
    v_mul_u32_u24 v20, 28, v7
    v_sub_u32 v6, v6, v20
    v_bfe_u32 v20, v7, 3, 1
    v_lshlrev_b32 v20, 1, v20
    v_xor_b32 v6, v6, v20
    v_mul_lo_u32 v7, v7, s45
    v_lshl_add_u32 v6, v6, 4, v7
    v_add_u32 v17, s46, v6
    s_mul_i32 s44, s35, 448
    s_add_u32 s44, s44, 384
    v_add_u32 v6, s44, v2
    v_mul_u32_u24 v7, 2341, v6
    v_lshrrev_b32 v7, 16, v7
    v_mul_u32_u24 v20, 28, v7
    v_sub_u32 v6, v6, v20
    v_bfe_u32 v20, v7, 3, 1
    v_lshlrev_b32 v20, 1, v20
    v_xor_b32 v6, v6, v20
    v_mul_lo_u32 v7, v7, s45
    v_lshl_add_u32 v6, v6, 4, v7
    v_add_u32 v18, s46, v6
    s_lshl_b32 s42, s35, 12
    s_mul_i32 s43, s35, 7168
    s_add_u32 s43, s43, 16384
    s_mov_b32 s38, 0x0
    s_mov_b32 s39, 0x0
    s_add_u32 m0, s43, 0x0
    s_nop 0
    buffer_load_dwordx4 v12, s[12:15], s39 offen lds
    s_add_u32 m0, s43, 0x400
    s_nop 0
    buffer_load_dwordx4 v13, s[12:15], s39 offen lds
    s_add_u32 m0, s43, 0x800
    s_nop 0
    buffer_load_dwordx4 v14, s[12:15], s39 offen lds
    s_add_u32 m0, s43, 0xc00
    s_nop 0
    buffer_load_dwordx4 v15, s[12:15], s39 offen lds
    s_add_u32 m0, s43, 0x1000
    s_nop 0
    buffer_load_dwordx4 v16, s[12:15], s39 offen lds
    s_add_u32 m0, s43, 0x1400
    s_nop 0
    buffer_load_dwordx4 v17, s[12:15], s39 offen lds
    s_add_u32 m0, s43, 0x1800
    s_nop 0
    buffer_load_dwordx4 v18, s[12:15], s39 offen lds
    s_mov_b32 s38, 0x80
    s_mov_b32 s39, 0x70000
    s_add_u32 m0, s43, 0xb000
    s_nop 0
    buffer_load_dwordx4 v12, s[12:15], s39 offen lds
    s_add_u32 m0, s43, 0xb400
    s_nop 0
    buffer_load_dwordx4 v13, s[12:15], s39 offen lds
    s_add_u32 m0, s43, 0xb800
    s_nop 0
    buffer_load_dwordx4 v14, s[12:15], s39 offen lds
    s_add_u32 m0, s43, 0xbc00
    s_nop 0
    buffer_load_dwordx4 v15, s[12:15], s39 offen lds
    s_add_u32 m0, s43, 0xc000
    s_nop 0
    buffer_load_dwordx4 v16, s[12:15], s39 offen lds
    s_add_u32 m0, s43, 0xc400
    s_nop 0
    buffer_load_dwordx4 v17, s[12:15], s39 offen lds
    s_add_u32 m0, s43, 0xc800
    s_nop 0
    buffer_load_dwordx4 v18, s[12:15], s39 offen lds
    s_mov_b32 s38, 0x100
    s_mov_b32 s39, 0xe0000
    s_add_u32 m0, s43, 0x16000
    s_nop 0
    buffer_load_dwordx4 v12, s[12:15], s39 offen lds
    s_add_u32 m0, s43, 0x16400
    s_nop 0
    buffer_load_dwordx4 v13, s[12:15], s39 offen lds
    s_add_u32 m0, s43, 0x16800
    s_nop 0
    buffer_load_dwordx4 v14, s[12:15], s39 offen lds
    s_add_u32 m0, s43, 0x16c00
    s_nop 0
    buffer_load_dwordx4 v15, s[12:15], s39 offen lds
    s_add_u32 m0, s43, 0x17000
    s_nop 0
    buffer_load_dwordx4 v16, s[12:15], s39 offen lds
    s_add_u32 m0, s43, 0x17400
    s_nop 0
    buffer_load_dwordx4 v17, s[12:15], s39 offen lds
    s_add_u32 m0, s43, 0x17800
    s_nop 0
    buffer_load_dwordx4 v18, s[12:15], s39 offen lds
    s_cmp_lg_u32 s35, 0
    s_cbranch_scc1 k3_kernel_dok
    s_add_u32 s20, s70, 0x1b20800
    s_addc_u32 s21, s71, 0
    s_mov_b32 s22, 0x800
    s_mov_b32 s23, 0x20000
    v_and_b32 v26, 15, v2
    v_lshrrev_b32 v27, 4, v2
    v_and_b32 v27, 1, v27
    v_mov_b32 v28, s48
    v_mov_b32 v29, s49
    v_cmp_eq_u32 vcc, 0, v27
    s_nop 1
    v_cndmask_b32 v27, v29, v28, vcc
    v_lshl_add_u32 v26, v27, 4, v26
    v_lshlrev_b32 v26, 3, v26
k3_kernel_dpoll:
    buffer_load_dwordx2 v[24:25], v26, s[20:23], 0 offen sc1
    s_waitcnt vmcnt(0)
    v_xor_b32 v24, s6, v24
    v_xor_b32 v25, s7, v25
    v_or_b32 v24, v24, v25
    v_cmp_ne_u32 vcc, 0, v24
    s_nop 4
    s_cmp_eq_u64 vcc, 0
    s_cbranch_scc0 k3_kernel_dpoll
k3_kernel_dok:
    s_barrier
    s_mov_b32 s38, 0x0
    s_mov_b32 s39, 0x0
    s_add_u32 m0, s42, 0x0
    s_nop 0
    buffer_load_dwordx4 v8, s[8:11], s38 offen sc1 lds
    s_add_u32 m0, s42, 0x400
    s_nop 0
    buffer_load_dwordx4 v9, s[8:11], s38 offen sc1 lds
    s_add_u32 m0, s42, 0x800
    s_nop 0
    buffer_load_dwordx4 v10, s[8:11], s38 offen sc1 lds
    s_add_u32 m0, s42, 0xc00
    s_nop 0
    buffer_load_dwordx4 v11, s[8:11], s38 offen sc1 lds
    s_mov_b32 s38, 0x80
    s_mov_b32 s39, 0x70000
    s_add_u32 m0, s42, 0xb000
    s_nop 0
    buffer_load_dwordx4 v8, s[8:11], s38 offen sc1 lds
    s_add_u32 m0, s42, 0xb400
    s_nop 0
    buffer_load_dwordx4 v9, s[8:11], s38 offen sc1 lds
    s_add_u32 m0, s42, 0xb800
    s_nop 0
    buffer_load_dwordx4 v10, s[8:11], s38 offen sc1 lds
    s_add_u32 m0, s42, 0xbc00
    s_nop 0
    buffer_load_dwordx4 v11, s[8:11], s38 offen sc1 lds
    s_add_u32 s20, s70, 0xa00000
    s_addc_u32 s21, s71, 0
    s_mov_b32 s22, 0xe40000
    s_mov_b32 s23, 0x20000
    s_add_u32 s24, s70, 0x1a00000
    s_addc_u32 s25, s71, 0
    s_mov_b32 s26, 0x40000
    s_mov_b32 s27, 0x20000
    s_add_u32 s28, s70, 0x1a40000
    s_addc_u32 s29, s71, 0
    s_mov_b32 s30, 0x38000
    s_mov_b32 s31, 0x20000
    s_waitcnt vmcnt(4)
    s_barrier
    s_mov_b32 s38, 0x100
    s_mov_b32 s39, 0xe0000
    s_add_u32 m0, s42, 0x16000
    s_nop 0
    buffer_load_dwordx4 v8, s[8:11], s38 offen sc1 lds
    s_add_u32 m0, s42, 0x16400
    s_nop 0
    buffer_load_dwordx4 v9, s[8:11], s38 offen sc1 lds
    s_add_u32 m0, s42, 0x16800
    s_nop 0
    buffer_load_dwordx4 v10, s[8:11], s38 offen sc1 lds
    s_add_u32 m0, s42, 0x16c00
    s_nop 0
    buffer_load_dwordx4 v11, s[8:11], s38 offen sc1 lds
    v_subrev_u32 v28, 256, v0
    v_and_b32 v5, 127, v28
    v_lshrrev_b32 v6, 7, v28
    v_add_u32 v7, s33, v5
    v_lshlrev_b32 v7, 3, v7
    v_lshl_add_u32 v7, v6, 17, v7
    s_mov_b32 s44, 0x0
    buffer_load_dwordx2 v[32:33], v7, s[24:27], s44 offen sc1
    s_mov_b32 s44, 0x4000
    buffer_load_dwordx2 v[34:35], v7, s[24:27], s44 offen sc1
    s_mov_b32 s44, 0x8000
    buffer_load_dwordx2 v[36:37], v7, s[24:27], s44 offen sc1
    s_mov_b32 s44, 0xc000
    buffer_load_dwordx2 v[38:39], v7, s[24:27], s44 offen sc1
    s_mov_b32 s44, 0x10000
    buffer_load_dwordx2 v[40:41], v7, s[24:27], s44 offen sc1
    s_mov_b32 s44, 0x14000
    buffer_load_dwordx2 v[42:43], v7, s[24:27], s44 offen sc1
    s_mov_b32 s44, 0x18000
    buffer_load_dwordx2 v[44:45], v7, s[24:27], s44 offen sc1
    s_mov_b32 s44, 0x1c000
    buffer_load_dwordx2 v[46:47], v7, s[24:27], s44 offen sc1
    v_add_u32 v22, s34, v28
    v_lshlrev_b32 v22, 2, v22
    v_cmp_gt_u32 vcc, 224, v28
    v_mov_b32 v23, 0x7ffffff0
    s_nop 0
    v_cndmask_b32 v22, v23, v22, vcc
    s_mov_b32 s44, 0x0
    buffer_load_dword v48, v22, s[28:31], s44 offen sc1
    s_mov_b32 s44, 0x3800
    buffer_load_dword v49, v22, s[28:31], s44 offen sc1
    s_mov_b32 s44, 0x7000
    buffer_load_dword v50, v22, s[28:31], s44 offen sc1
    s_mov_b32 s44, 0xa800
    buffer_load_dword v51, v22, s[28:31], s44 offen sc1
    s_mov_b32 s44, 0xe000
    buffer_load_dword v52, v22, s[28:31], s44 offen sc1
    s_mov_b32 s44, 0x11800
    buffer_load_dword v53, v22, s[28:31], s44 offen sc1
    s_mov_b32 s44, 0x15000
    buffer_load_dword v54, v22, s[28:31], s44 offen sc1
    s_mov_b32 s44, 0x18800
    buffer_load_dword v55, v22, s[28:31], s44 offen sc1
    s_mov_b32 s44, 0x1c000
    buffer_load_dword v56, v22, s[28:31], s44 offen sc1
    s_mov_b32 s44, 0x1f800
    buffer_load_dword v57, v22, s[28:31], s44 offen sc1
    s_mov_b32 s44, 0x23000
    buffer_load_dword v58, v22, s[28:31], s44 offen sc1
    s_mov_b32 s44, 0x26800
    buffer_load_dword v59, v22, s[28:31], s44 offen sc1
    s_mov_b32 s44, 0x2a000
    buffer_load_dword v60, v22, s[28:31], s44 offen sc1
    s_mov_b32 s44, 0x2d800
    buffer_load_dword v61, v22, s[28:31], s44 offen sc1
    s_mov_b32 s44, 0x31000
    buffer_load_dword v62, v22, s[28:31], s44 offen sc1
    s_mov_b32 s44, 0x34800
    buffer_load_dword v63, v22, s[28:31], s44 offen sc1
    s_waitcnt vmcnt(28)
    s_barrier
    s_mov_b32 s38, 0x180
    s_mov_b32 s39, 0x150000
    s_add_u32 m0, s42, 0x0
    s_nop 0
    buffer_load_dwordx4 v8, s[8:11], s38 offen sc1 lds
    s_add_u32 m0, s42, 0x400
    s_nop 0
    buffer_load_dwordx4 v9, s[8:11], s38 offen sc1 lds
    s_add_u32 m0, s42, 0x800
    s_nop 0
    buffer_load_dwordx4 v10, s[8:11], s38 offen sc1 lds
    s_add_u32 m0, s42, 0xc00
    s_nop 0
    buffer_load_dwordx4 v11, s[8:11], s38 offen sc1 lds
    s_add_u32 m0, s43, 0x0
    s_nop 0
    buffer_load_dwordx4 v12, s[12:15], s39 offen lds
    s_add_u32 m0, s43, 0x400
    s_nop 0
    buffer_load_dwordx4 v13, s[12:15], s39 offen lds
    s_add_u32 m0, s43, 0x800
    s_nop 0
    buffer_load_dwordx4 v14, s[12:15], s39 offen lds
    s_add_u32 m0, s43, 0xc00
    s_nop 0
    buffer_load_dwordx4 v15, s[12:15], s39 offen lds
    s_add_u32 m0, s43, 0x1000
    s_nop 0
    buffer_load_dwordx4 v16, s[12:15], s39 offen lds
    s_add_u32 m0, s43, 0x1400
    s_nop 0
    buffer_load_dwordx4 v17, s[12:15], s39 offen lds
    s_add_u32 m0, s43, 0x1800
    s_nop 0
    buffer_load_dwordx4 v18, s[12:15], s39 offen lds
    s_waitcnt vmcnt(35)
    s_barrier
    s_mov_b32 s38, 0x200
    s_mov_b32 s39, 0x1c0000
    s_add_u32 m0, s42, 0xb000
    s_nop 0
    buffer_load_dwordx4 v8, s[8:11], s38 offen sc1 lds
    s_add_u32 m0, s42, 0xb400
    s_nop 0
    buffer_load_dwordx4 v9, s[8:11], s38 offen sc1 lds
    s_add_u32 m0, s42, 0xb800
    s_nop 0
    buffer_load_dwordx4 v10, s[8:11], s38 offen sc1 lds
    s_add_u32 m0, s42, 0xbc00
    s_nop 0
    buffer_load_dwordx4 v11, s[8:11], s38 offen sc1 lds
    s_add_u32 m0, s43, 0xb000
    s_nop 0
    buffer_load_dwordx4 v12, s[12:15], s39 offen lds
    s_add_u32 m0, s43, 0xb400
    s_nop 0
    buffer_load_dwordx4 v13, s[12:15], s39 offen lds
    s_add_u32 m0, s43, 0xb800
    s_nop 0
    buffer_load_dwordx4 v14, s[12:15], s39 offen lds
    s_add_u32 m0, s43, 0xbc00
    s_nop 0
    buffer_load_dwordx4 v15, s[12:15], s39 offen lds
    s_add_u32 m0, s43, 0xc000
    s_nop 0
    buffer_load_dwordx4 v16, s[12:15], s39 offen lds
    s_add_u32 m0, s43, 0xc400
    s_nop 0
    buffer_load_dwordx4 v17, s[12:15], s39 offen lds
    s_add_u32 m0, s43, 0xc800
    s_nop 0
    buffer_load_dwordx4 v18, s[12:15], s39 offen lds
    s_waitcnt vmcnt(11)
    s_barrier
    s_mov_b32 s38, 0x280
    s_mov_b32 s39, 0x230000
    s_add_u32 m0, s42, 0x16000
    s_nop 0
    buffer_load_dwordx4 v8, s[8:11], s38 offen sc1 lds
    s_add_u32 m0, s42, 0x16400
    s_nop 0
    buffer_load_dwordx4 v9, s[8:11], s38 offen sc1 lds
    s_add_u32 m0, s42, 0x16800
    s_nop 0
    buffer_load_dwordx4 v10, s[8:11], s38 offen sc1 lds
    s_add_u32 m0, s42, 0x16c00
    s_nop 0
    buffer_load_dwordx4 v11, s[8:11], s38 offen sc1 lds
    s_add_u32 m0, s43, 0x16000
    s_nop 0
    buffer_load_dwordx4 v12, s[12:15], s39 offen lds
    s_add_u32 m0, s43, 0x16400
    s_nop 0
    buffer_load_dwordx4 v13, s[12:15], s39 offen lds
    s_add_u32 m0, s43, 0x16800
    s_nop 0
    buffer_load_dwordx4 v14, s[12:15], s39 offen lds
    s_add_u32 m0, s43, 0x16c00
    s_nop 0
    buffer_load_dwordx4 v15, s[12:15], s39 offen lds
    s_add_u32 m0, s43, 0x17000
    s_nop 0
    buffer_load_dwordx4 v16, s[12:15], s39 offen lds
    s_add_u32 m0, s43, 0x17400
    s_nop 0
    buffer_load_dwordx4 v17, s[12:15], s39 offen lds
    s_add_u32 m0, s43, 0x17800
    s_nop 0
    buffer_load_dwordx4 v18, s[12:15], s39 offen lds
    v_add_f32 v32, v32, v34
    v_add_f32 v33, v33, v35
    v_add_f32 v32, v32, v36
    v_add_f32 v33, v33, v37
    v_add_f32 v32, v32, v38
    v_add_f32 v33, v33, v39
    v_add_f32 v32, v32, v40
    v_add_f32 v33, v33, v41
    v_add_f32 v32, v32, v42
    v_add_f32 v33, v33, v43
    v_add_f32 v32, v32, v44
    v_add_f32 v33, v33, v45
    v_add_f32 v32, v32, v46
    v_add_f32 v33, v33, v47
    v_and_b32 v5, 127, v28
    v_lshrrev_b32 v6, 7, v28
    v_lshlrev_b32 v5, 3, v5
    v_lshl_add_u32 v5, v6, 10, v5
    v_add_u32 v5, 0x21000, v5
    ds_write_b64 v5, v[32:33]
    v_add_f32 v48, v48, v49
    v_add_f32 v48, v48, v50
    v_add_f32 v48, v48, v51
    v_add_f32 v48, v48, v52
    v_add_f32 v48, v48, v53
    v_add_f32 v48, v48, v54
    v_add_f32 v48, v48, v55
    v_add_f32 v48, v48, v56
    v_add_f32 v48, v48, v57
    v_add_f32 v48, v48, v58
    v_add_f32 v48, v48, v59
    v_add_f32 v48, v48, v60
    v_add_f32 v48, v48, v61
    v_add_f32 v48, v48, v62
    v_add_f32 v48, v48, v63
    v_lshlrev_b32 v5, 2, v28
    v_add_u32 v5, 0x21800, v5
    ds_write_b32 v5, v48
    s_waitcnt lgkmcnt(0)
    s_waitcnt vmcnt(11)
    s_barrier
    s_mov_b32 s38, 0x300
    s_mov_b32 s39, 0x2a0000
    s_add_u32 m0, s42, 0x0
    s_nop 0
    buffer_load_dwordx4 v8, s[8:11], s38 offen sc1 lds
    s_add_u32 m0, s42, 0x400
    s_nop 0
    buffer_load_dwordx4 v9, s[8:11], s38 offen sc1 lds
    s_add_u32 m0, s42, 0x800
    s_nop 0
    buffer_load_dwordx4 v10, s[8:11], s38 offen sc1 lds
    s_add_u32 m0, s42, 0xc00
    s_nop 0
    buffer_load_dwordx4 v11, s[8:11], s38 offen sc1 lds
    s_add_u32 m0, s43, 0x0
    s_nop 0
    buffer_load_dwordx4 v12, s[12:15], s39 offen lds
    s_add_u32 m0, s43, 0x400
    s_nop 0
    buffer_load_dwordx4 v13, s[12:15], s39 offen lds
    s_add_u32 m0, s43, 0x800
    s_nop 0
    buffer_load_dwordx4 v14, s[12:15], s39 offen lds
    s_add_u32 m0, s43, 0xc00
    s_nop 0
    buffer_load_dwordx4 v15, s[12:15], s39 offen lds
    s_add_u32 m0, s43, 0x1000
    s_nop 0
    buffer_load_dwordx4 v16, s[12:15], s39 offen lds
    s_add_u32 m0, s43, 0x1400
    s_nop 0
    buffer_load_dwordx4 v17, s[12:15], s39 offen lds
    s_add_u32 m0, s43, 0x1800
    s_nop 0
    buffer_load_dwordx4 v18, s[12:15], s39 offen lds
    s_cmp_gt_u32 s35, 1
    s_cbranch_scc1 k3_kernel_pcs
    v_lshlrev_b32 v5, 3, v28
    v_add_u32 v5, 0x21000, v5
    ds_read_b64 v[32:33], v5
    ds_read_b64 v[34:35], v5 offset:1024
    s_waitcnt lgkmcnt(0)
    v_add_f32 v32, v32, v34
    v_add_f32 v33, v33, v35
    v_mul_f32 v32, 0x3a800000, v32
    v_mul_f32 v33, 0x3a800000, v33
    v_fma_f32 v33, -v32, v32, v33
    v_max_f32 v33, 0, v33
    v_cvt_pk_bf16_f32 v32, v32, v33
    v_lshlrev_b32 v36, 16, v32
    v_and_b32 v33, s52, v32
    v_xor_b32 v36, 0x80000000, v36
    v_add_f32 v33, 0x3727c5ac, v33
    v_cvt_pk_bf16_f32 v33, v33, v33
    v_and_b32 v33, s52, v33
    v_sqrt_f32 v33, v33
    s_nop 0
    v_cvt_pk_bf16_f32 v33, v33, v33
    v_and_b32 v39, s52, v33
    v_rcp_f32 v33, v39
    s_nop 0
    v_mul_f32 v37, s50, v33
    v_mul_f32 v32, v33, v33
    v_mul_f32 v32, v32, v33
    v_mul_f32 v38, s51, v32
    v_lshlrev_b32 v5, 4, v28
    v_add_u32 v5, 0x22000, v5
    ds_write_b128 v5, v[36:39]
    s_waitcnt lgkmcnt(0)
k3_kernel_pcs:
    s_waitcnt vmcnt(11)
    s_barrier
    s_mov_b32 s38, 0x380
    s_mov_b32 s39, 0x310000
    s_add_u32 m0, s42, 0xb000
    s_nop 0
    buffer_load_dwordx4 v8, s[8:11], s38 offen sc1 lds
    s_add_u32 m0, s42, 0xb400
    s_nop 0
    buffer_load_dwordx4 v9, s[8:11], s38 offen sc1 lds
    s_add_u32 m0, s42, 0xb800
    s_nop 0
    buffer_load_dwordx4 v10, s[8:11], s38 offen sc1 lds
    s_add_u32 m0, s42, 0xbc00
    s_nop 0
    buffer_load_dwordx4 v11, s[8:11], s38 offen sc1 lds
    s_add_u32 m0, s43, 0xb000
    s_nop 0
    buffer_load_dwordx4 v12, s[12:15], s39 offen lds
    s_add_u32 m0, s43, 0xb400
    s_nop 0
    buffer_load_dwordx4 v13, s[12:15], s39 offen lds
    s_add_u32 m0, s43, 0xb800
    s_nop 0
    buffer_load_dwordx4 v14, s[12:15], s39 offen lds
    s_add_u32 m0, s43, 0xbc00
    s_nop 0
    buffer_load_dwordx4 v15, s[12:15], s39 offen lds
    s_add_u32 m0, s43, 0xc000
    s_nop 0
    buffer_load_dwordx4 v16, s[12:15], s39 offen lds
    s_add_u32 m0, s43, 0xc400
    s_nop 0
    buffer_load_dwordx4 v17, s[12:15], s39 offen lds
    s_add_u32 m0, s43, 0xc800
    s_nop 0
    buffer_load_dwordx4 v18, s[12:15], s39 offen lds
    s_waitcnt vmcnt(11)
    s_barrier
    s_mov_b32 s38, 0x400
    s_mov_b32 s39, 0x380000
    s_add_u32 m0, s42, 0x16000
    s_nop 0
    buffer_load_dwordx4 v8, s[8:11], s38 offen sc1 lds
    s_add_u32 m0, s42, 0x16400
    s_nop 0
    buffer_load_dwordx4 v9, s[8:11], s38 offen sc1 lds
    s_add_u32 m0, s42, 0x16800
    s_nop 0
    buffer_load_dwordx4 v10, s[8:11], s38 offen sc1 lds
    s_add_u32 m0, s42, 0x16c00
    s_nop 0
    buffer_load_dwordx4 v11, s[8:11], s38 offen sc1 lds
    s_add_u32 m0, s43, 0x16000
    s_nop 0
    buffer_load_dwordx4 v12, s[12:15], s39 offen lds
    s_add_u32 m0, s43, 0x16400
    s_nop 0
    buffer_load_dwordx4 v13, s[12:15], s39 offen lds
    s_add_u32 m0, s43, 0x16800
    s_nop 0
    buffer_load_dwordx4 v14, s[12:15], s39 offen lds
    s_add_u32 m0, s43, 0x16c00
    s_nop 0
    buffer_load_dwordx4 v15, s[12:15], s39 offen lds
    s_add_u32 m0, s43, 0x17000
    s_nop 0
    buffer_load_dwordx4 v16, s[12:15], s39 offen lds
    s_add_u32 m0, s43, 0x17400
    s_nop 0
    buffer_load_dwordx4 v17, s[12:15], s39 offen lds
    s_add_u32 m0, s43, 0x17800
    s_nop 0
    buffer_load_dwordx4 v18, s[12:15], s39 offen lds
    s_waitcnt vmcnt(11)
    s_barrier
    s_mov_b32 s38, 0x480
    s_mov_b32 s39, 0x3f0000
    s_add_u32 m0, s42, 0x0
    s_nop 0
    buffer_load_dwordx4 v8, s[8:11], s38 offen sc1 lds
    s_add_u32 m0, s42, 0x400
    s_nop 0
    buffer_load_dwordx4 v9, s[8:11], s38 offen sc1 lds
    s_add_u32 m0, s42, 0x800
    s_nop 0
    buffer_load_dwordx4 v10, s[8:11], s38 offen sc1 lds
    s_add_u32 m0, s42, 0xc00
    s_nop 0
    buffer_load_dwordx4 v11, s[8:11], s38 offen sc1 lds
    s_add_u32 m0, s43, 0x0
    s_nop 0
    buffer_load_dwordx4 v12, s[12:15], s39 offen lds
    s_add_u32 m0, s43, 0x400
    s_nop 0
    buffer_load_dwordx4 v13, s[12:15], s39 offen lds
    s_add_u32 m0, s43, 0x800
    s_nop 0
    buffer_load_dwordx4 v14, s[12:15], s39 offen lds
    s_add_u32 m0, s43, 0xc00
    s_nop 0
    buffer_load_dwordx4 v15, s[12:15], s39 offen lds
    s_add_u32 m0, s43, 0x1000
    s_nop 0
    buffer_load_dwordx4 v16, s[12:15], s39 offen lds
    s_add_u32 m0, s43, 0x1400
    s_nop 0
    buffer_load_dwordx4 v17, s[12:15], s39 offen lds
    s_add_u32 m0, s43, 0x1800
    s_nop 0
    buffer_load_dwordx4 v18, s[12:15], s39 offen lds
    s_waitcnt vmcnt(11)
    s_barrier
    s_mov_b32 s38, 0x500
    s_mov_b32 s39, 0x460000
    s_add_u32 m0, s42, 0xb000
    s_nop 0
    buffer_load_dwordx4 v8, s[8:11], s38 offen sc1 lds
    s_add_u32 m0, s42, 0xb400
    s_nop 0
    buffer_load_dwordx4 v9, s[8:11], s38 offen sc1 lds
    s_add_u32 m0, s42, 0xb800
    s_nop 0
    buffer_load_dwordx4 v10, s[8:11], s38 offen sc1 lds
    s_add_u32 m0, s42, 0xbc00
    s_nop 0
    buffer_load_dwordx4 v11, s[8:11], s38 offen sc1 lds
    s_add_u32 m0, s43, 0xb000
    s_nop 0
    buffer_load_dwordx4 v12, s[12:15], s39 offen lds
    s_add_u32 m0, s43, 0xb400
    s_nop 0
    buffer_load_dwordx4 v13, s[12:15], s39 offen lds
    s_add_u32 m0, s43, 0xb800
    s_nop 0
    buffer_load_dwordx4 v14, s[12:15], s39 offen lds
    s_add_u32 m0, s43, 0xbc00
    s_nop 0
    buffer_load_dwordx4 v15, s[12:15], s39 offen lds
    s_add_u32 m0, s43, 0xc000
    s_nop 0
    buffer_load_dwordx4 v16, s[12:15], s39 offen lds
    s_add_u32 m0, s43, 0xc400
    s_nop 0
    buffer_load_dwordx4 v17, s[12:15], s39 offen lds
    s_add_u32 m0, s43, 0xc800
    s_nop 0
    buffer_load_dwordx4 v18, s[12:15], s39 offen lds
    s_waitcnt vmcnt(11)
    s_barrier
    s_mov_b32 s38, 0x580
    s_mov_b32 s39, 0x4d0000
    s_add_u32 m0, s42, 0x16000
    s_nop 0
    buffer_load_dwordx4 v8, s[8:11], s38 offen sc1 lds
    s_add_u32 m0, s42, 0x16400
    s_nop 0
    buffer_load_dwordx4 v9, s[8:11], s38 offen sc1 lds
    s_add_u32 m0, s42, 0x16800
    s_nop 0
    buffer_load_dwordx4 v10, s[8:11], s38 offen sc1 lds
    s_add_u32 m0, s42, 0x16c00
    s_nop 0
    buffer_load_dwordx4 v11, s[8:11], s38 offen sc1 lds
    s_add_u32 m0, s43, 0x16000
    s_nop 0
    buffer_load_dwordx4 v12, s[12:15], s39 offen lds
    s_add_u32 m0, s43, 0x16400
    s_nop 0
    buffer_load_dwordx4 v13, s[12:15], s39 offen lds
    s_add_u32 m0, s43, 0x16800
    s_nop 0
    buffer_load_dwordx4 v14, s[12:15], s39 offen lds
    s_add_u32 m0, s43, 0x16c00
    s_nop 0
    buffer_load_dwordx4 v15, s[12:15], s39 offen lds
    s_add_u32 m0, s43, 0x17000
    s_nop 0
    buffer_load_dwordx4 v16, s[12:15], s39 offen lds
    s_add_u32 m0, s43, 0x17400
    s_nop 0
    buffer_load_dwordx4 v17, s[12:15], s39 offen lds
    s_add_u32 m0, s43, 0x17800
    s_nop 0
    buffer_load_dwordx4 v18, s[12:15], s39 offen lds
    s_waitcnt vmcnt(11)
    s_barrier
    s_mov_b32 s38, 0x600
    s_mov_b32 s39, 0x540000
    s_add_u32 m0, s42, 0x0
    s_nop 0
    buffer_load_dwordx4 v8, s[8:11], s38 offen sc1 lds
    s_add_u32 m0, s42, 0x400
    s_nop 0
    buffer_load_dwordx4 v9, s[8:11], s38 offen sc1 lds
    s_add_u32 m0, s42, 0x800
    s_nop 0
    buffer_load_dwordx4 v10, s[8:11], s38 offen sc1 lds
    s_add_u32 m0, s42, 0xc00
    s_nop 0
    buffer_load_dwordx4 v11, s[8:11], s38 offen sc1 lds
    s_add_u32 m0, s43, 0x0
    s_nop 0
    buffer_load_dwordx4 v12, s[12:15], s39 offen lds
    s_add_u32 m0, s43, 0x400
    s_nop 0
    buffer_load_dwordx4 v13, s[12:15], s39 offen lds
    s_add_u32 m0, s43, 0x800
    s_nop 0
    buffer_load_dwordx4 v14, s[12:15], s39 offen lds
    s_add_u32 m0, s43, 0xc00
    s_nop 0
    buffer_load_dwordx4 v15, s[12:15], s39 offen lds
    s_add_u32 m0, s43, 0x1000
    s_nop 0
    buffer_load_dwordx4 v16, s[12:15], s39 offen lds
    s_add_u32 m0, s43, 0x1400
    s_nop 0
    buffer_load_dwordx4 v17, s[12:15], s39 offen lds
    s_add_u32 m0, s43, 0x1800
    s_nop 0
    buffer_load_dwordx4 v18, s[12:15], s39 offen lds
    s_waitcnt vmcnt(11)
    s_barrier
    s_mov_b32 s38, 0x680
    s_mov_b32 s39, 0x5b0000
    s_add_u32 m0, s42, 0xb000
    s_nop 0
    buffer_load_dwordx4 v8, s[8:11], s38 offen sc1 lds
    s_add_u32 m0, s42, 0xb400
    s_nop 0
    buffer_load_dwordx4 v9, s[8:11], s38 offen sc1 lds
    s_add_u32 m0, s42, 0xb800
    s_nop 0
    buffer_load_dwordx4 v10, s[8:11], s38 offen sc1 lds
    s_add_u32 m0, s42, 0xbc00
    s_nop 0
    buffer_load_dwordx4 v11, s[8:11], s38 offen sc1 lds
    s_add_u32 m0, s43, 0xb000
    s_nop 0
    buffer_load_dwordx4 v12, s[12:15], s39 offen lds
    s_add_u32 m0, s43, 0xb400
    s_nop 0
    buffer_load_dwordx4 v13, s[12:15], s39 offen lds
    s_add_u32 m0, s43, 0xb800
    s_nop 0
    buffer_load_dwordx4 v14, s[12:15], s39 offen lds
    s_add_u32 m0, s43, 0xbc00
    s_nop 0
    buffer_load_dwordx4 v15, s[12:15], s39 offen lds
    s_add_u32 m0, s43, 0xc000
    s_nop 0
    buffer_load_dwordx4 v16, s[12:15], s39 offen lds
    s_add_u32 m0, s43, 0xc400
    s_nop 0
    buffer_load_dwordx4 v17, s[12:15], s39 offen lds
    s_add_u32 m0, s43, 0xc800
    s_nop 0
    buffer_load_dwordx4 v18, s[12:15], s39 offen lds
    s_waitcnt vmcnt(11)
    s_barrier
    s_mov_b32 s38, 0x700
    s_mov_b32 s39, 0x620000
    s_add_u32 m0, s42, 0x16000
    s_nop 0
    buffer_load_dwordx4 v8, s[8:11], s38 offen sc1 lds
    s_add_u32 m0, s42, 0x16400
    s_nop 0
    buffer_load_dwordx4 v9, s[8:11], s38 offen sc1 lds
    s_add_u32 m0, s42, 0x16800
    s_nop 0
    buffer_load_dwordx4 v10, s[8:11], s38 offen sc1 lds
    s_add_u32 m0, s42, 0x16c00
    s_nop 0
    buffer_load_dwordx4 v11, s[8:11], s38 offen sc1 lds
    s_add_u32 m0, s43, 0x16000
    s_nop 0
    buffer_load_dwordx4 v12, s[12:15], s39 offen lds
    s_add_u32 m0, s43, 0x16400
    s_nop 0
    buffer_load_dwordx4 v13, s[12:15], s39 offen lds
    s_add_u32 m0, s43, 0x16800
    s_nop 0
    buffer_load_dwordx4 v14, s[12:15], s39 offen lds
    s_add_u32 m0, s43, 0x16c00
    s_nop 0
    buffer_load_dwordx4 v15, s[12:15], s39 offen lds
    s_add_u32 m0, s43, 0x17000
    s_nop 0
    buffer_load_dwordx4 v16, s[12:15], s39 offen lds
    s_add_u32 m0, s43, 0x17400
    s_nop 0
    buffer_load_dwordx4 v17, s[12:15], s39 offen lds
    s_add_u32 m0, s43, 0x17800
    s_nop 0
    buffer_load_dwordx4 v18, s[12:15], s39 offen lds
    s_waitcnt vmcnt(11)
    s_barrier
    s_mov_b32 s38, 0x780
    s_mov_b32 s39, 0x690000
    s_add_u32 m0, s42, 0x0
    s_nop 0
    buffer_load_dwordx4 v8, s[8:11], s38 offen sc1 lds
    s_add_u32 m0, s42, 0x400
    s_nop 0
    buffer_load_dwordx4 v9, s[8:11], s38 offen sc1 lds
    s_add_u32 m0, s42, 0x800
    s_nop 0
    buffer_load_dwordx4 v10, s[8:11], s38 offen sc1 lds
    s_add_u32 m0, s42, 0xc00
    s_nop 0
    buffer_load_dwordx4 v11, s[8:11], s38 offen sc1 lds
    s_add_u32 m0, s43, 0x0
    s_nop 0
    buffer_load_dwordx4 v12, s[12:15], s39 offen lds
    s_add_u32 m0, s43, 0x400
    s_nop 0
    buffer_load_dwordx4 v13, s[12:15], s39 offen lds
    s_add_u32 m0, s43, 0x800
    s_nop 0
    buffer_load_dwordx4 v14, s[12:15], s39 offen lds
    s_add_u32 m0, s43, 0xc00
    s_nop 0
    buffer_load_dwordx4 v15, s[12:15], s39 offen lds
    s_add_u32 m0, s43, 0x1000
    s_nop 0
    buffer_load_dwordx4 v16, s[12:15], s39 offen lds
    s_add_u32 m0, s43, 0x1400
    s_nop 0
    buffer_load_dwordx4 v17, s[12:15], s39 offen lds
    s_add_u32 m0, s43, 0x1800
    s_nop 0
    buffer_load_dwordx4 v18, s[12:15], s39 offen lds
    s_waitcnt vmcnt(11)
    s_barrier
    s_waitcnt vmcnt(0)
    s_barrier
    s_barrier
    s_mul_i32 s44, s35, 224
    s_add_u32 s44, s44, 0
    v_add_u32 v6, s44, v2
    v_mul_u32_u24 v7, 2341, v6
    v_lshrrev_b32 v7, 16, v7
    v_mul_u32_u24 v20, 28, v7
    v_sub_u32 v6, v6, v20
    v_and_b32 v20, 15, v7
    v_lshrrev_b32 v7, 4, v7
    v_lshl_add_u32 v7, v7, 6, v20
    v_mul_u32_u24 v20, 464, v7
    v_lshl_add_u32 v24, v6, 4, v20
    v_add_u32 v7, s33, v7
    s_mov_b32 s45, 7296
    v_mul_lo_u32 v7, v7, s45
    v_lshl_add_u32 v7, v6, 4, v7
    s_lshl_b32 s45, s34, 1
    v_add_u32 v28, s45, v7
    s_mul_i32 s44, s35, 224
    s_add_u32 s44, s44, 64
    v_add_u32 v6, s44, v2
    v_mul_u32_u24 v7, 2341, v6
    v_lshrrev_b32 v7, 16, v7
    v_mul_u32_u24 v20, 28, v7
    v_sub_u32 v6, v6, v20
    v_and_b32 v20, 15, v7
    v_lshrrev_b32 v7, 4, v7
    v_lshl_add_u32 v7, v7, 6, v20
    v_mul_u32_u24 v20, 464, v7
    v_lshl_add_u32 v25, v6, 4, v20
    v_add_u32 v7, s33, v7
    s_mov_b32 s45, 7296
    v_mul_lo_u32 v7, v7, s45
    v_lshl_add_u32 v7, v6, 4, v7
    s_lshl_b32 s45, s34, 1
    v_add_u32 v29, s45, v7
    s_mul_i32 s44, s35, 224
    s_add_u32 s44, s44, 128
    v_add_u32 v6, s44, v2
    v_mul_u32_u24 v7, 2341, v6
    v_lshrrev_b32 v7, 16, v7
    v_mul_u32_u24 v20, 28, v7
    v_sub_u32 v6, v6, v20
    v_and_b32 v20, 15, v7
    v_lshrrev_b32 v7, 4, v7
    v_lshl_add_u32 v7, v7, 6, v20
    v_mul_u32_u24 v20, 464, v7
    v_lshl_add_u32 v26, v6, 4, v20
    v_add_u32 v7, s33, v7
    s_mov_b32 s45, 7296
    v_mul_lo_u32 v7, v7, s45
    v_lshl_add_u32 v7, v6, 4, v7
    s_lshl_b32 s45, s34, 1
    v_add_u32 v30, s45, v7
    s_mul_i32 s44, s35, 224
    s_add_u32 s44, s44, 192
    v_add_u32 v6, s44, v2
    v_mul_u32_u24 v7, 2341, v6
    v_lshrrev_b32 v7, 16, v7
    v_mul_u32_u24 v20, 28, v7
    v_sub_u32 v6, v6, v20
    v_and_b32 v20, 15, v7
    v_lshrrev_b32 v7, 4, v7
    v_lshl_add_u32 v7, v7, 6, v20
    v_mul_u32_u24 v20, 464, v7
    v_lshl_add_u32 v27, v6, 4, v20
    v_add_u32 v7, s33, v7
    s_mov_b32 s45, 7296
    v_mul_lo_u32 v7, v7, s45
    v_lshl_add_u32 v7, v6, 4, v7
    s_lshl_b32 s45, s34, 1
    v_add_u32 v31, s45, v7
    v_cmp_gt_u32 vcc, 32, v2
    v_mov_b32 v20, 0x7ffffff0
    v_mov_b32 v21, 0
    v_cndmask_b32 v31, v20, v31, vcc
    v_cndmask_b32 v27, v21, v27, vcc
    s_barrier
    ds_read_b128 v[32:35], v24 offset:0
    ds_read_b128 v[36:39], v25 offset:0
    ds_read_b128 v[40:43], v26 offset:0
    ds_read_b128 v[44:47], v27 offset:0
    s_mov_b32 s44, 0
    s_waitcnt lgkmcnt(3)
    buffer_store_dwordx4 v[32:35], v28, s[20:23], s44 offen sc1
    s_waitcnt lgkmcnt(2)
    buffer_store_dwordx4 v[36:39], v29, s[20:23], s44 offen sc1
    s_waitcnt lgkmcnt(1)
    buffer_store_dwordx4 v[40:43], v30, s[20:23], s44 offen sc1
    s_waitcnt lgkmcnt(0)
    buffer_store_dwordx4 v[44:47], v31, s[20:23], s44 offen sc1
    s_barrier
    ds_read_b128 v[48:51], v24 offset:7424
    ds_read_b128 v[52:55], v25 offset:7424
    ds_read_b128 v[56:59], v26 offset:7424
    ds_read_b128 v[60:63], v27 offset:7424
    s_mov_b32 s44, 116736
    s_waitcnt lgkmcnt(3)
    buffer_store_dwordx4 v[48:51], v28, s[20:23], s44 offen sc1
    s_waitcnt lgkmcnt(2)
    buffer_store_dwordx4 v[52:55], v29, s[20:23], s44 offen sc1
    s_waitcnt lgkmcnt(1)
    buffer_store_dwordx4 v[56:59], v30, s[20:23], s44 offen sc1
    s_waitcnt lgkmcnt(0)
    buffer_store_dwordx4 v[60:63], v31, s[20:23], s44 offen sc1
    s_barrier
    ds_read_b128 v[32:35], v24 offset:14848
    ds_read_b128 v[36:39], v25 offset:14848
    ds_read_b128 v[40:43], v26 offset:14848
    ds_read_b128 v[44:47], v27 offset:14848
    s_mov_b32 s44, 233472
    s_waitcnt lgkmcnt(3)
    buffer_store_dwordx4 v[32:35], v28, s[20:23], s44 offen sc1
    s_waitcnt lgkmcnt(2)
    buffer_store_dwordx4 v[36:39], v29, s[20:23], s44 offen sc1
    s_waitcnt lgkmcnt(1)
    buffer_store_dwordx4 v[40:43], v30, s[20:23], s44 offen sc1
    s_waitcnt lgkmcnt(0)
    buffer_store_dwordx4 v[44:47], v31, s[20:23], s44 offen sc1
    s_barrier
    ds_read_b128 v[48:51], v24 offset:22272
    ds_read_b128 v[52:55], v25 offset:22272
    ds_read_b128 v[56:59], v26 offset:22272
    ds_read_b128 v[60:63], v27 offset:22272
    s_mov_b32 s44, 350208
    s_waitcnt lgkmcnt(3)
    buffer_store_dwordx4 v[48:51], v28, s[20:23], s44 offen sc1
    s_waitcnt lgkmcnt(2)
    buffer_store_dwordx4 v[52:55], v29, s[20:23], s44 offen sc1
    s_waitcnt lgkmcnt(1)
    buffer_store_dwordx4 v[56:59], v30, s[20:23], s44 offen sc1
    s_waitcnt lgkmcnt(0)
    buffer_store_dwordx4 v[60:63], v31, s[20:23], s44 offen sc1
    s_branch k3_kernel_fin
k3_kernel_store:
k3_kernel_fin:
    s_waitcnt vmcnt(0) lgkmcnt(0)
k3_kernel_finnw:
k3_kernel_pskip:
    s_barrier
    s_cmp_lg_u32 s32, 4
    s_cbranch_scc1 k4_kernel
    s_add_u32 s24, s70, 0x1b21000
    s_addc_u32 s25, s71, 0
    s_mov_b32 s26, 0x800
    s_mov_b32 s27, 0x20000
    s_lshl_b32 s44, s48, 4
    s_add_u32 s44, s44, s49
    s_lshl_b32 s44, s44, 3
    v_and_b32 v2, 63, v0
    v_mov_b32 v22, s44
    v_mov_b32 v23, 0x7ffffff0
    v_cmp_eq_u32 vcc, 0, v2
    v_mov_b32 v24, s6
    v_mov_b32 v25, s7
    v_cndmask_b32 v22, v23, v22, vcc
    buffer_store_dwordx2 v[24:25], v22, s[24:27], 0 offen sc1
    s_branch k4_kernel
k3_kernel_cons:
    s_lshr_b32 s36, s32, 1
    s_and_b32 s37, s32, 1
    v_and_b32 v3, 15, v2
    v_lshrrev_b32 v4, 4, v2
    s_lshl_b32 s44, s36, 13
    v_lshlrev_b32 v5, 7, v3
    v_lshrrev_b32 v6, 1, v3
    v_xor_b32 v6, v6, v4
    v_lshlrev_b32 v6, 4, v6
    v_add3_u32 v8, v5, v6, s44
    v_xor_b32 v9, 64, v8
    v_lshrrev_b32 v5, 2, v3
    v_lshl_add_u32 v6, v4, 3, v5
    v_and_b32 v7, 3, v2
    v_mul_u32_u24 v6, 448, v6
    v_lshl_add_u32 v6, v7, 3, v6
    s_mul_i32 s44, s37, 224
    s_add_u32 s44, s44, 16384
    v_add_u32 v6, s44, v6
    v_and_b32 v7, 1, v4
    v_lshlrev_b32 v7, 5, v7
    v_add_u32 v5, v6, v7
    v_sub_u32 v6, v6, v7
    s_cmp_eq_u32 s37, 0
    s_cselect_b64 vcc, -1, 0
    v_cndmask_b32 v12, v6, v5, vcc
    v_cndmask_b32 v13, v5, v6, vcc
    v_mov_b32 v128, 0
    v_mov_b32 v129, 0
    v_mov_b32 v130, 0
    v_mov_b32 v131, 0
    v_mov_b32 v132, 0
    v_mov_b32 v133, 0
    v_mov_b32 v134, 0
    v_mov_b32 v135, 0
    v_mov_b32 v136, 0
    v_mov_b32 v137, 0
    v_mov_b32 v138, 0
    v_mov_b32 v139, 0
    v_mov_b32 v140, 0
    v_mov_b32 v141, 0
    v_mov_b32 v142, 0
    v_mov_b32 v143, 0
    v_mov_b32 v144, 0
    v_mov_b32 v145, 0
    v_mov_b32 v146, 0
    v_mov_b32 v147, 0
    v_mov_b32 v148, 0
    v_mov_b32 v149, 0
    v_mov_b32 v150, 0
    v_mov_b32 v151, 0
    v_mov_b32 v152, 0
    v_mov_b32 v153, 0
    v_mov_b32 v154, 0
    v_mov_b32 v155, 0
    v_mov_b32 v156, 0
    v_mov_b32 v157, 0
    v_mov_b32 v158, 0
    v_mov_b32 v159, 0
    v_mov_b32 v160, 0
    v_mov_b32 v161, 0
    v_mov_b32 v162, 0
    v_mov_b32 v163, 0
    v_mov_b32 v164, 0
    v_mov_b32 v165, 0
    v_mov_b32 v166, 0
    v_mov_b32 v167, 0
    v_mov_b32 v168, 0
    v_mov_b32 v169, 0
    v_mov_b32 v170, 0
    v_mov_b32 v171, 0
    v_mov_b32 v172, 0
    v_mov_b32 v173, 0
    v_mov_b32 v174, 0
    v_mov_b32 v175, 0
    v_mov_b32 v176, 0
    v_mov_b32 v177, 0
    v_mov_b32 v178, 0
    v_mov_b32 v179, 0
    v_mov_b32 v180, 0
    v_mov_b32 v181, 0
    v_mov_b32 v182, 0
    v_mov_b32 v183, 0
    v_mov_b32 v184, 0
    v_mov_b32 v185, 0
    v_mov_b32 v186, 0
    v_mov_b32 v187, 0
    v_mov_b32 v188, 0
    v_mov_b32 v189, 0
    v_mov_b32 v190, 0
    v_mov_b32 v191, 0
    v_mov_b32 v192, 0
    v_mov_b32 v193, 0
    v_mov_b32 v194, 0
    v_mov_b32 v195, 0
    v_mov_b32 v196, 0
    v_mov_b32 v197, 0
    v_mov_b32 v198, 0
    v_mov_b32 v199, 0
    v_mov_b32 v200, 0
    v_mov_b32 v201, 0
    v_mov_b32 v202, 0
    v_mov_b32 v203, 0
    v_mov_b32 v204, 0
    v_mov_b32 v205, 0
    v_mov_b32 v206, 0
    v_mov_b32 v207, 0
    v_mov_b32 v208, 0
    v_mov_b32 v209, 0
    v_mov_b32 v210, 0
    v_mov_b32 v211, 0
    v_mov_b32 v212, 0
    v_mov_b32 v213, 0
    v_mov_b32 v214, 0
    v_mov_b32 v215, 0
    v_mov_b32 v216, 0
    v_mov_b32 v217, 0
    v_mov_b32 v218, 0
    v_mov_b32 v219, 0
    v_mov_b32 v220, 0
    v_mov_b32 v221, 0
    v_mov_b32 v222, 0
    v_mov_b32 v223, 0
    v_mov_b32 v224, 0
    v_mov_b32 v225, 0
    v_mov_b32 v226, 0
    v_mov_b32 v227, 0
    v_mov_b32 v228, 0
    v_mov_b32 v229, 0
    v_mov_b32 v230, 0
    v_mov_b32 v231, 0
    v_mov_b32 v232, 0
    v_mov_b32 v233, 0
    v_mov_b32 v234, 0
    v_mov_b32 v235, 0
    v_mov_b32 v236, 0
    v_mov_b32 v237, 0
    v_mov_b32 v238, 0
    v_mov_b32 v239, 0
    s_add_u32 s20, s70, 0xa00000
    s_addc_u32 s21, s71, 0
    s_mov_b32 s22, 0xe40000
    s_mov_b32 s23, 0x20000
    s_add_u32 s24, s70, 0x1a00000
    s_addc_u32 s25, s71, 0
    s_mov_b32 s26, 0x40000
    s_mov_b32 s27, 0x20000
    s_add_u32 s28, s70, 0x1a40000
    s_addc_u32 s29, s71, 0
    s_mov_b32 s30, 0x38000
    s_mov_b32 s31, 0x20000
    s_mov_b32 s41, 0
    s_mov_b32 s40, 16
    s_barrier
    s_barrier
    v_add_u32 v10, s41, v8
    v_add_u32 v11, s41, v9
    v_add_u32 v16, s41, v12
    v_add_u32 v17, s41, v13
    ds_read_b128 v[32:35], v10 offset:0
    ds_read_b64_tr_b16 v[48:49], v16 offset:0
    ds_read_b64_tr_b16 v[50:51], v16 offset:1792
    ds_read_b128 v[36:39], v10 offset:2048
    ds_read_b128 v[40:43], v10 offset:4096
    ds_read_b128 v[44:47], v10 offset:6144
    ds_read_b64_tr_b16 v[52:53], v17 offset:32
    ds_read_b64_tr_b16 v[54:55], v17 offset:1824
    ds_read_b64_tr_b16 v[56:57], v16 offset:64
    ds_read_b64_tr_b16 v[58:59], v16 offset:1856
    ds_read_b64_tr_b16 v[60:61], v17 offset:96
    ds_read_b64_tr_b16 v[62:63], v17 offset:1888
    ds_read_b64_tr_b16 v[64:65], v16 offset:128
    ds_read_b64_tr_b16 v[66:67], v16 offset:1920
    ds_read_b64_tr_b16 v[68:69], v17 offset:160
    ds_read_b64_tr_b16 v[70:71], v17 offset:1952
    ds_read_b64_tr_b16 v[72:73], v16 offset:192
    ds_read_b64_tr_b16 v[74:75], v16 offset:1984
k3_kernel_loop:
    s_cmp_eq_u32 s40, 14
    s_cbranch_scc1 k3_kernel_pfat0
k3_kernel_pfat0_r:
    s_cmp_eq_u32 s40, 11
    s_cbranch_scc1 k3_kernel_pfat1
k3_kernel_pfat1_r:
    s_cmp_eq_u32 s40, 8
    s_cbranch_scc1 k3_kernel_pfat2
k3_kernel_pfat2_r:
    s_cmp_eq_u32 s40, 5
    s_cbranch_scc1 k3_kernel_pfat3
k3_kernel_pfat3_r:
    s_cmp_eq_u32 s40, 4
    s_cbranch_scc1 k3_kernel_pfat4
k3_kernel_pfat4_r:
    s_cmp_eq_u32 s40, 3
    s_cbranch_scc1 k3_kernel_pfat5
k3_kernel_pfat5_r:
    s_cmp_eq_u32 s40, 2
    s_cbranch_scc1 k3_kernel_pfat6
k3_kernel_pfat6_r:
    s_waitcnt lgkmcnt(0)
    v_mfma_f32_16x16x32_bf16 v[128:131], v[48:51], v[32:35], v[128:131]
    ds_read_b128 v[76:79], v11 offset:0
    v_mfma_f32_16x16x32_bf16 v[156:159], v[48:51], v[36:39], v[156:159]
    ds_read_b64_tr_b16 v[92:93], v16 offset:14336
    v_mfma_f32_16x16x32_bf16 v[184:187], v[48:51], v[40:43], v[184:187]
    ds_read_b64_tr_b16 v[94:95], v16 offset:16128
    v_mfma_f32_16x16x32_bf16 v[212:215], v[48:51], v[44:47], v[212:215]
    ds_read_b128 v[80:83], v11 offset:2048
    v_mfma_f32_16x16x32_bf16 v[132:135], v[52:55], v[32:35], v[132:135]
    ds_read_b128 v[84:87], v11 offset:4096
    v_mfma_f32_16x16x32_bf16 v[160:163], v[52:55], v[36:39], v[160:163]
    ds_read_b128 v[88:91], v11 offset:6144
    v_mfma_f32_16x16x32_bf16 v[188:191], v[52:55], v[40:43], v[188:191]
    ds_read_b64_tr_b16 v[96:97], v17 offset:14368
    v_mfma_f32_16x16x32_bf16 v[216:219], v[52:55], v[44:47], v[216:219]
    ds_read_b64_tr_b16 v[98:99], v17 offset:16160
    v_mfma_f32_16x16x32_bf16 v[136:139], v[56:59], v[32:35], v[136:139]
    ds_read_b64_tr_b16 v[100:101], v16 offset:14400
    v_mfma_f32_16x16x32_bf16 v[164:167], v[56:59], v[36:39], v[164:167]
    ds_read_b64_tr_b16 v[102:103], v16 offset:16192
    v_mfma_f32_16x16x32_bf16 v[192:195], v[56:59], v[40:43], v[192:195]
    ds_read_b64_tr_b16 v[104:105], v17 offset:14432
    v_mfma_f32_16x16x32_bf16 v[220:223], v[56:59], v[44:47], v[220:223]
    ds_read_b64_tr_b16 v[106:107], v17 offset:16224
    v_mfma_f32_16x16x32_bf16 v[140:143], v[60:63], v[32:35], v[140:143]
    ds_read_b64_tr_b16 v[108:109], v16 offset:14464
    v_mfma_f32_16x16x32_bf16 v[168:171], v[60:63], v[36:39], v[168:171]
    ds_read_b64_tr_b16 v[110:111], v16 offset:16256
    v_mfma_f32_16x16x32_bf16 v[196:199], v[60:63], v[40:43], v[196:199]
    ds_read_b64_tr_b16 v[112:113], v17 offset:14496
    v_mfma_f32_16x16x32_bf16 v[224:227], v[60:63], v[44:47], v[224:227]
    ds_read_b64_tr_b16 v[114:115], v17 offset:16288
    v_mfma_f32_16x16x32_bf16 v[144:147], v[64:67], v[32:35], v[144:147]
    ds_read_b64_tr_b16 v[116:117], v16 offset:14528
    v_mfma_f32_16x16x32_bf16 v[172:175], v[64:67], v[36:39], v[172:175]
    ds_read_b64_tr_b16 v[118:119], v16 offset:16320
    v_mfma_f32_16x16x32_bf16 v[200:203], v[64:67], v[40:43], v[200:203]
    v_mfma_f32_16x16x32_bf16 v[228:231], v[64:67], v[44:47], v[228:231]
    v_mfma_f32_16x16x32_bf16 v[148:151], v[68:71], v[32:35], v[148:151]
    v_mfma_f32_16x16x32_bf16 v[176:179], v[68:71], v[36:39], v[176:179]
    v_mfma_f32_16x16x32_bf16 v[204:207], v[68:71], v[40:43], v[204:207]
    v_mfma_f32_16x16x32_bf16 v[232:235], v[68:71], v[44:47], v[232:235]
    v_mfma_f32_16x16x32_bf16 v[152:155], v[72:75], v[32:35], v[152:155]
    v_mfma_f32_16x16x32_bf16 v[180:183], v[72:75], v[36:39], v[180:183]
    v_mfma_f32_16x16x32_bf16 v[208:211], v[72:75], v[40:43], v[208:211]
    v_mfma_f32_16x16x32_bf16 v[236:239], v[72:75], v[44:47], v[236:239]
    s_add_u32 s41, s41, 45056
    s_cmp_eq_u32 s41, 135168
    s_cselect_b32 s41, 0, s41
    v_add_u32 v10, s41, v8
    v_add_u32 v16, s41, v12
    v_add_u32 v17, s41, v13
    s_waitcnt lgkmcnt(0)
    s_barrier
    v_mfma_f32_16x16x32_bf16 v[128:131], v[92:95], v[76:79], v[128:131]
    ds_read_b128 v[32:35], v10 offset:0
    v_mfma_f32_16x16x32_bf16 v[156:159], v[92:95], v[80:83], v[156:159]
    ds_read_b64_tr_b16 v[48:49], v16 offset:0
    v_mfma_f32_16x16x32_bf16 v[184:187], v[92:95], v[84:87], v[184:187]
    ds_read_b64_tr_b16 v[50:51], v16 offset:1792
    v_mfma_f32_16x16x32_bf16 v[212:215], v[92:95], v[88:91], v[212:215]
    ds_read_b128 v[36:39], v10 offset:2048
    v_mfma_f32_16x16x32_bf16 v[132:135], v[96:99], v[76:79], v[132:135]
    ds_read_b128 v[40:43], v10 offset:4096
    v_mfma_f32_16x16x32_bf16 v[160:163], v[96:99], v[80:83], v[160:163]
    ds_read_b128 v[44:47], v10 offset:6144
    v_mfma_f32_16x16x32_bf16 v[188:191], v[96:99], v[84:87], v[188:191]
    ds_read_b64_tr_b16 v[52:53], v17 offset:32
    v_mfma_f32_16x16x32_bf16 v[216:219], v[96:99], v[88:91], v[216:219]
    ds_read_b64_tr_b16 v[54:55], v17 offset:1824
    v_mfma_f32_16x16x32_bf16 v[136:139], v[100:103], v[76:79], v[136:139]
    ds_read_b64_tr_b16 v[56:57], v16 offset:64
    v_mfma_f32_16x16x32_bf16 v[164:167], v[100:103], v[80:83], v[164:167]
    ds_read_b64_tr_b16 v[58:59], v16 offset:1856
    v_mfma_f32_16x16x32_bf16 v[192:195], v[100:103], v[84:87], v[192:195]
    ds_read_b64_tr_b16 v[60:61], v17 offset:96
    v_mfma_f32_16x16x32_bf16 v[220:223], v[100:103], v[88:91], v[220:223]
    ds_read_b64_tr_b16 v[62:63], v17 offset:1888
    v_mfma_f32_16x16x32_bf16 v[140:143], v[104:107], v[76:79], v[140:143]
    ds_read_b64_tr_b16 v[64:65], v16 offset:128
    v_mfma_f32_16x16x32_bf16 v[168:171], v[104:107], v[80:83], v[168:171]
    ds_read_b64_tr_b16 v[66:67], v16 offset:1920
    v_mfma_f32_16x16x32_bf16 v[196:199], v[104:107], v[84:87], v[196:199]
    ds_read_b64_tr_b16 v[68:69], v17 offset:160
    v_mfma_f32_16x16x32_bf16 v[224:227], v[104:107], v[88:91], v[224:227]
    ds_read_b64_tr_b16 v[70:71], v17 offset:1952
    v_mfma_f32_16x16x32_bf16 v[144:147], v[108:111], v[76:79], v[144:147]
    ds_read_b64_tr_b16 v[72:73], v16 offset:192
    v_mfma_f32_16x16x32_bf16 v[172:175], v[108:111], v[80:83], v[172:175]
    ds_read_b64_tr_b16 v[74:75], v16 offset:1984
    v_mfma_f32_16x16x32_bf16 v[200:203], v[108:111], v[84:87], v[200:203]
    v_mfma_f32_16x16x32_bf16 v[228:231], v[108:111], v[88:91], v[228:231]
    v_mfma_f32_16x16x32_bf16 v[148:151], v[112:115], v[76:79], v[148:151]
    v_mfma_f32_16x16x32_bf16 v[176:179], v[112:115], v[80:83], v[176:179]
    v_mfma_f32_16x16x32_bf16 v[204:207], v[112:115], v[84:87], v[204:207]
    v_mfma_f32_16x16x32_bf16 v[232:235], v[112:115], v[88:91], v[232:235]
    v_mfma_f32_16x16x32_bf16 v[152:155], v[116:119], v[76:79], v[152:155]
    v_mfma_f32_16x16x32_bf16 v[180:183], v[116:119], v[80:83], v[180:183]
    v_mfma_f32_16x16x32_bf16 v[208:211], v[116:119], v[84:87], v[208:211]
    v_mfma_f32_16x16x32_bf16 v[236:239], v[116:119], v[88:91], v[236:239]
    v_add_u32 v11, s41, v9
    s_sub_u32 s40, s40, 1
    s_cmp_lg_u32 s40, 0
    s_cbranch_scc1 k3_kernel_loop
    s_branch k3_kernel_after
k3_kernel_pfat0:
    s_cmp_lg_u32 s32, 0
    s_cbranch_scc1 k3_kernel_pfat0_r
    s_mov_b32 s72, s64
    s_mov_b32 s73, s65
    s_mov_b32 s74, 0x700000
    s_mov_b32 s75, 0x20000
    s_lshr_b32 s44, s53, 0
    s_and_b32 s44, s44, 7
    s_mul_i32 s44, s44, 448
    s_mul_i32 s45, s54, 14
    s_add_u32 s44, s44, s45
    s_mul_i32 s45, s32, 4
    s_add_u32 s44, s44, s45
    s_lshr_b32 s45, s53, 0
    s_and_b32 s45, s45, 0
    s_mul_i32 s45, s45, 0
    v_lshrrev_b32 v6, 4, v2
    v_add_u32 v6, s44, v6
    s_mov_b32 s46, 2048
    v_mul_lo_u32 v6, v6, s46
    v_and_b32 v7, 15, v2
    v_lshl_add_u32 v6, v7, 7, v6
    v_add_u32 v6, s45, v6
    s_mov_b32 s46, 0
    buffer_load_dword v250, v6, s[72:75], s46 offen
    s_branch k3_kernel_pfat0_r
k3_kernel_pfat1:
    s_cmp_lg_u32 s32, 1
    s_cbranch_scc1 k3_kernel_pfat1_r
    s_mov_b32 s72, s64
    s_mov_b32 s73, s65
    s_mov_b32 s74, 0x700000
    s_mov_b32 s75, 0x20000
    s_lshr_b32 s44, s53, 0
    s_and_b32 s44, s44, 7
    s_mul_i32 s44, s44, 448
    s_mul_i32 s45, s54, 14
    s_add_u32 s44, s44, s45
    s_mul_i32 s45, s32, 4
    s_add_u32 s44, s44, s45
    s_lshr_b32 s45, s53, 0
    s_and_b32 s45, s45, 0
    s_mul_i32 s45, s45, 0
    v_lshrrev_b32 v6, 4, v2
    v_add_u32 v6, s44, v6
    s_mov_b32 s46, 2048
    v_mul_lo_u32 v6, v6, s46
    v_and_b32 v7, 15, v2
    v_lshl_add_u32 v6, v7, 7, v6
    v_add_u32 v6, s45, v6
    s_mov_b32 s46, 0
    buffer_load_dword v250, v6, s[72:75], s46 offen
    s_branch k3_kernel_pfat1_r
k3_kernel_pfat2:
    s_cmp_lg_u32 s32, 2
    s_cbranch_scc1 k3_kernel_pfat2_r
    s_mov_b32 s72, s64
    s_mov_b32 s73, s65
    s_mov_b32 s74, 0x700000
    s_mov_b32 s75, 0x20000
    s_lshr_b32 s44, s53, 0
    s_and_b32 s44, s44, 7
    s_mul_i32 s44, s44, 448
    s_mul_i32 s45, s54, 14
    s_add_u32 s44, s44, s45
    s_mul_i32 s45, s32, 4
    s_add_u32 s44, s44, s45
    s_lshr_b32 s45, s53, 0
    s_and_b32 s45, s45, 0
    s_mul_i32 s45, s45, 0
    v_lshrrev_b32 v6, 4, v2
    v_add_u32 v6, s44, v6
    s_mov_b32 s46, 2048
    v_mul_lo_u32 v6, v6, s46
    v_and_b32 v7, 15, v2
    v_lshl_add_u32 v6, v7, 7, v6
    v_add_u32 v6, s45, v6
    s_mov_b32 s46, 0
    buffer_load_dword v250, v6, s[72:75], s46 offen
    s_branch k3_kernel_pfat2_r
k3_kernel_pfat3:
    s_cmp_lg_u32 s32, 3
    s_cbranch_scc1 k3_kernel_pfat3_r
    s_mov_b32 s72, s64
    s_mov_b32 s73, s65
    s_mov_b32 s74, 0x700000
    s_mov_b32 s75, 0x20000
    s_lshr_b32 s44, s53, 0
    s_and_b32 s44, s44, 7
    s_mul_i32 s44, s44, 448
    s_mul_i32 s45, s54, 14
    s_add_u32 s44, s44, s45
    s_mul_i32 s45, s32, 4
    s_add_u32 s44, s44, s45
    s_lshr_b32 s45, s53, 0
    s_and_b32 s45, s45, 0
    s_mul_i32 s45, s45, 0
    v_lshrrev_b32 v6, 4, v2
    v_add_u32 v6, s44, v6
    s_mov_b32 s46, 2048
    v_mul_lo_u32 v6, v6, s46
    v_and_b32 v7, 15, v2
    v_lshl_add_u32 v6, v7, 7, v6
    v_add_u32 v6, s45, v6
    s_mov_b32 s46, 0
    buffer_load_dword v250, v6, s[72:75], s46 offen
    s_branch k3_kernel_pfat3_r
k3_kernel_pfat4:
    s_cmp_lg_u32 s32, 3
    s_cbranch_scc1 k3_kernel_pfat4_r
    s_getpc_b64 s[4:5]
k3_kernel_cpf1:
    s_sub_u32 s4, s4, k3_kernel_cpf1-k3_kernel
    s_subb_u32 s5, s5, 0
    s_and_b32 s44, s54, 1
    s_lshl_b32 s44, s44, 13
    v_lshlrev_b32 v6, 7, v2
    v_add_u32 v6, s44, v6
    v_min_u32 v6, k3_kernel_end-k3_kernel-4, v6
    global_load_dword v250, v6, s[4:5]
    s_branch k3_kernel_pfat4_r
k3_kernel_pfat5:
    s_cmp_lg_u32 s32, 3
    s_cbranch_scc1 k3_kernel_pfat5_r
    s_getpc_b64 s[4:5]
k3_kernel_cpf2:
    s_add_u32 s4, s4, k4_kernel-k3_kernel_cpf2
    s_addc_u32 s5, s5, 0
    s_and_b32 s44, s54, 1
    s_lshl_b32 s44, s44, 13
    v_lshlrev_b32 v6, 7, v2
    v_add_u32 v6, s44, v6
    v_min_u32 v6, k4_kernel_end-k4_kernel-4, v6
    global_load_dword v250, v6, s[4:5]
    s_branch k3_kernel_pfat5_r
k3_kernel_pfat6:
    s_cmp_lg_u32 s32, 2
    s_cbranch_scc1 k3_kernel_pfat6_r
    s_mov_b32 s72, s64
    s_mov_b32 s73, s65
    s_mov_b32 s74, 0x700000
    s_mov_b32 s75, 0x20000
    s_and_b32 s45, s53, 1
    s_mul_i32 s45, s45, 1792
    s_lshl_b32 s44, s54, 6
    s_add_u32 s44, s44, s45
    v_add_u32 v6, s44, v2
    v_lshlrev_b32 v6, 11, v6
    s_lshr_b32 s44, s53, 2
    s_lshl_b32 s44, s44, 10
    s_add_u32 s44, s44, 384
    buffer_load_dword v250, v6, s[72:75], s44 offen
    s_branch k3_kernel_pfat6_r
k3_kernel_after:
    s_waitcnt lgkmcnt(0)
    s_nop 7
    s_nop 7
    v_and_b32 v3, 15, v2
    v_lshrrev_b32 v4, 4, v2
    s_mul_i32 s44, s36, 29696
    s_mul_i32 s45, s37, 224
    s_add_u32 s44, s44, s45
    v_mul_u32_u24 v5, 464, v3
    v_lshl_add_u32 v5, v4, 3, v5
    v_add_u32 v5, s44, v5
    s_lshl_b32 s44, s36, 6
    v_add_u32 v6, s44, v3
    v_lshlrev_b32 v6, 4, v6
    v_add_u32 v6, 0x22000, v6
    ds_read_b128 v[32:35], v6 offset:0
    ds_read_b128 v[36:39], v6 offset:256
    ds_read_b128 v[40:43], v6 offset:512
    ds_read_b128 v[44:47], v6 offset:768
    s_mul_i32 s44, s37, 448
    s_add_u32 s44, s44, 0x21800
    v_lshlrev_b32 v10, 4, v4
    v_add_u32 v10, s44, v10
    ds_read_b128 v[80:83], v10 offset:0
    ds_read_b128 v[84:87], v10 offset:64
    ds_read_b128 v[88:91], v10 offset:128
    ds_read_b128 v[92:95], v10 offset:192
    ds_read_b128 v[96:99], v10 offset:256
    ds_read_b128 v[100:103], v10 offset:320
    ds_read_b128 v[104:107], v10 offset:384
    s_waitcnt lgkmcnt(0)
    v_pk_fma_f32 v[128:129], v[80:81], v[32:33], v[128:129] op_sel_hi:[1,0,1]
    v_pk_fma_f32 v[130:131], v[82:83], v[32:33], v[130:131] op_sel_hi:[1,0,1]
    v_pk_fma_f32 v[132:133], v[84:85], v[32:33], v[132:133] op_sel_hi:[1,0,1]
    v_pk_fma_f32 v[134:135], v[86:87], v[32:33], v[134:135] op_sel_hi:[1,0,1]
    v_pk_fma_f32 v[136:137], v[88:89], v[32:33], v[136:137] op_sel_hi:[1,0,1]
    v_pk_fma_f32 v[138:139], v[90:91], v[32:33], v[138:139] op_sel_hi:[1,0,1]
    v_pk_fma_f32 v[140:141], v[92:93], v[32:33], v[140:141] op_sel_hi:[1,0,1]
    v_pk_fma_f32 v[142:143], v[94:95], v[32:33], v[142:143] op_sel_hi:[1,0,1]
    v_pk_mul_f32 v[16:17], v[128:129], v[128:129]
    v_pk_mul_f32 v[18:19], v[130:131], v[130:131]
    v_pk_mul_f32 v[20:21], v[132:133], v[132:133]
    v_pk_mul_f32 v[22:23], v[134:135], v[134:135]
    v_pk_mul_f32 v[24:25], v[136:137], v[136:137]
    v_pk_mul_f32 v[26:27], v[138:139], v[138:139]
    v_pk_mul_f32 v[28:29], v[140:141], v[140:141]
    v_pk_mul_f32 v[30:31], v[142:143], v[142:143]
    v_pk_fma_f32 v[16:17], v[16:17], v[34:35], v[32:33] op_sel:[0,0,1] op_sel_hi:[1,0,1]
    v_pk_fma_f32 v[18:19], v[18:19], v[34:35], v[32:33] op_sel:[0,0,1] op_sel_hi:[1,0,1]
    v_pk_fma_f32 v[20:21], v[20:21], v[34:35], v[32:33] op_sel:[0,0,1] op_sel_hi:[1,0,1]
    v_pk_fma_f32 v[22:23], v[22:23], v[34:35], v[32:33] op_sel:[0,0,1] op_sel_hi:[1,0,1]
    v_pk_fma_f32 v[24:25], v[24:25], v[34:35], v[32:33] op_sel:[0,0,1] op_sel_hi:[1,0,1]
    v_pk_fma_f32 v[26:27], v[26:27], v[34:35], v[32:33] op_sel:[0,0,1] op_sel_hi:[1,0,1]
    v_pk_fma_f32 v[28:29], v[28:29], v[34:35], v[32:33] op_sel:[0,0,1] op_sel_hi:[1,0,1]
    v_pk_fma_f32 v[30:31], v[30:31], v[34:35], v[32:33] op_sel:[0,0,1] op_sel_hi:[1,0,1]
    v_pk_mul_f32 v[16:17], v[16:17], v[128:129]
    v_pk_mul_f32 v[18:19], v[18:19], v[130:131]
    v_pk_mul_f32 v[20:21], v[20:21], v[132:133]
    v_pk_mul_f32 v[22:23], v[22:23], v[134:135]
    v_pk_mul_f32 v[24:25], v[24:25], v[136:137]
    v_pk_mul_f32 v[26:27], v[26:27], v[138:139]
    v_pk_mul_f32 v[28:29], v[28:29], v[140:141]
    v_pk_mul_f32 v[30:31], v[30:31], v[142:143]
    v_exp_f32 v16, v16
    v_exp_f32 v17, v17
    v_exp_f32 v18, v18
    v_exp_f32 v19, v19
    v_exp_f32 v20, v20
    v_exp_f32 v21, v21
    v_exp_f32 v22, v22
    v_exp_f32 v23, v23
    v_exp_f32 v24, v24
    v_exp_f32 v25, v25
    v_exp_f32 v26, v26
    v_exp_f32 v27, v27
    v_exp_f32 v28, v28
    v_exp_f32 v29, v29
    v_exp_f32 v30, v30
    v_exp_f32 v31, v31
    v_pk_fma_f32 v[16:17], v[16:17], v[34:35], v[34:35] op_sel:[0,1,1] op_sel_hi:[1,1,1]
    v_pk_fma_f32 v[18:19], v[18:19], v[34:35], v[34:35] op_sel:[0,1,1] op_sel_hi:[1,1,1]
    v_pk_fma_f32 v[20:21], v[20:21], v[34:35], v[34:35] op_sel:[0,1,1] op_sel_hi:[1,1,1]
    v_pk_fma_f32 v[22:23], v[22:23], v[34:35], v[34:35] op_sel:[0,1,1] op_sel_hi:[1,1,1]
    v_pk_fma_f32 v[24:25], v[24:25], v[34:35], v[34:35] op_sel:[0,1,1] op_sel_hi:[1,1,1]
    v_pk_fma_f32 v[26:27], v[26:27], v[34:35], v[34:35] op_sel:[0,1,1] op_sel_hi:[1,1,1]
    v_pk_fma_f32 v[28:29], v[28:29], v[34:35], v[34:35] op_sel:[0,1,1] op_sel_hi:[1,1,1]
    v_pk_fma_f32 v[30:31], v[30:31], v[34:35], v[34:35] op_sel:[0,1,1] op_sel_hi:[1,1,1]
    v_rcp_f32 v16, v16
    v_rcp_f32 v17, v17
    v_rcp_f32 v18, v18
    v_rcp_f32 v19, v19
    v_rcp_f32 v20, v20
    v_rcp_f32 v21, v21
    v_rcp_f32 v22, v22
    v_rcp_f32 v23, v23
    v_rcp_f32 v24, v24
    v_rcp_f32 v25, v25
    v_rcp_f32 v26, v26
    v_rcp_f32 v27, v27
    v_rcp_f32 v28, v28
    v_rcp_f32 v29, v29
    v_rcp_f32 v30, v30
    v_rcp_f32 v31, v31
    v_pk_mul_f32 v[128:129], v[128:129], v[16:17]
    v_pk_mul_f32 v[130:131], v[130:131], v[18:19]
    v_pk_mul_f32 v[132:133], v[132:133], v[20:21]
    v_pk_mul_f32 v[134:135], v[134:135], v[22:23]
    v_pk_mul_f32 v[136:137], v[136:137], v[24:25]
    v_pk_mul_f32 v[138:139], v[138:139], v[26:27]
    v_pk_mul_f32 v[140:141], v[140:141], v[28:29]
    v_pk_mul_f32 v[142:143], v[142:143], v[30:31]
    v_cvt_pk_bf16_f32 v128, v128, v129
    v_cvt_pk_bf16_f32 v129, v130, v131
    v_cvt_pk_bf16_f32 v132, v132, v133
    v_cvt_pk_bf16_f32 v133, v134, v135
    v_cvt_pk_bf16_f32 v136, v136, v137
    v_cvt_pk_bf16_f32 v137, v138, v139
    v_cvt_pk_bf16_f32 v140, v140, v141
    v_cvt_pk_bf16_f32 v141, v142, v143
    ds_write_b64 v5, v[128:129] offset:0
    ds_write_b64 v5, v[132:133] offset:32
    ds_write_b64 v5, v[136:137] offset:64
    ds_write_b64 v5, v[140:141] offset:96
    v_pk_fma_f32 v[144:145], v[96:97], v[32:33], v[144:145] op_sel_hi:[1,0,1]
    v_pk_fma_f32 v[146:147], v[98:99], v[32:33], v[146:147] op_sel_hi:[1,0,1]
    v_pk_fma_f32 v[148:149], v[100:101], v[32:33], v[148:149] op_sel_hi:[1,0,1]
    v_pk_fma_f32 v[150:151], v[102:103], v[32:33], v[150:151] op_sel_hi:[1,0,1]
    v_pk_fma_f32 v[152:153], v[104:105], v[32:33], v[152:153] op_sel_hi:[1,0,1]
    v_pk_fma_f32 v[154:155], v[106:107], v[32:33], v[154:155] op_sel_hi:[1,0,1]
    v_pk_mul_f32 v[16:17], v[144:145], v[144:145]
    v_pk_mul_f32 v[18:19], v[146:147], v[146:147]
    v_pk_mul_f32 v[20:21], v[148:149], v[148:149]
    v_pk_mul_f32 v[22:23], v[150:151], v[150:151]
    v_pk_mul_f32 v[24:25], v[152:153], v[152:153]
    v_pk_mul_f32 v[26:27], v[154:155], v[154:155]
    v_pk_fma_f32 v[16:17], v[16:17], v[34:35], v[32:33] op_sel:[0,0,1] op_sel_hi:[1,0,1]
    v_pk_fma_f32 v[18:19], v[18:19], v[34:35], v[32:33] op_sel:[0,0,1] op_sel_hi:[1,0,1]
    v_pk_fma_f32 v[20:21], v[20:21], v[34:35], v[32:33] op_sel:[0,0,1] op_sel_hi:[1,0,1]
    v_pk_fma_f32 v[22:23], v[22:23], v[34:35], v[32:33] op_sel:[0,0,1] op_sel_hi:[1,0,1]
    v_pk_fma_f32 v[24:25], v[24:25], v[34:35], v[32:33] op_sel:[0,0,1] op_sel_hi:[1,0,1]
    v_pk_fma_f32 v[26:27], v[26:27], v[34:35], v[32:33] op_sel:[0,0,1] op_sel_hi:[1,0,1]
    v_pk_mul_f32 v[16:17], v[16:17], v[144:145]
    v_pk_mul_f32 v[18:19], v[18:19], v[146:147]
    v_pk_mul_f32 v[20:21], v[20:21], v[148:149]
    v_pk_mul_f32 v[22:23], v[22:23], v[150:151]
    v_pk_mul_f32 v[24:25], v[24:25], v[152:153]
    v_pk_mul_f32 v[26:27], v[26:27], v[154:155]
    v_exp_f32 v16, v16
    v_exp_f32 v17, v17
    v_exp_f32 v18, v18
    v_exp_f32 v19, v19
    v_exp_f32 v20, v20
    v_exp_f32 v21, v21
    v_exp_f32 v22, v22
    v_exp_f32 v23, v23
    v_exp_f32 v24, v24
    v_exp_f32 v25, v25
    v_exp_f32 v26, v26
    v_exp_f32 v27, v27
    v_pk_fma_f32 v[16:17], v[16:17], v[34:35], v[34:35] op_sel:[0,1,1] op_sel_hi:[1,1,1]
    v_pk_fma_f32 v[18:19], v[18:19], v[34:35], v[34:35] op_sel:[0,1,1] op_sel_hi:[1,1,1]
    v_pk_fma_f32 v[20:21], v[20:21], v[34:35], v[34:35] op_sel:[0,1,1] op_sel_hi:[1,1,1]
    v_pk_fma_f32 v[22:23], v[22:23], v[34:35], v[34:35] op_sel:[0,1,1] op_sel_hi:[1,1,1]
    v_pk_fma_f32 v[24:25], v[24:25], v[34:35], v[34:35] op_sel:[0,1,1] op_sel_hi:[1,1,1]
    v_pk_fma_f32 v[26:27], v[26:27], v[34:35], v[34:35] op_sel:[0,1,1] op_sel_hi:[1,1,1]
    v_rcp_f32 v16, v16
    v_rcp_f32 v17, v17
    v_rcp_f32 v18, v18
    v_rcp_f32 v19, v19
    v_rcp_f32 v20, v20
    v_rcp_f32 v21, v21
    v_rcp_f32 v22, v22
    v_rcp_f32 v23, v23
    v_rcp_f32 v24, v24
    v_rcp_f32 v25, v25
    v_rcp_f32 v26, v26
    v_rcp_f32 v27, v27
    v_pk_mul_f32 v[144:145], v[144:145], v[16:17]
    v_pk_mul_f32 v[146:147], v[146:147], v[18:19]
    v_pk_mul_f32 v[148:149], v[148:149], v[20:21]
    v_pk_mul_f32 v[150:151], v[150:151], v[22:23]
    v_pk_mul_f32 v[152:153], v[152:153], v[24:25]
    v_pk_mul_f32 v[154:155], v[154:155], v[26:27]
    v_cvt_pk_bf16_f32 v144, v144, v145
    v_cvt_pk_bf16_f32 v145, v146, v147
    v_cvt_pk_bf16_f32 v148, v148, v149
    v_cvt_pk_bf16_f32 v149, v150, v151
    v_cvt_pk_bf16_f32 v152, v152, v153
    v_cvt_pk_bf16_f32 v153, v154, v155
    ds_write_b64 v5, v[144:145] offset:128
    ds_write_b64 v5, v[148:149] offset:160
    ds_write_b64 v5, v[152:153] offset:192
    s_waitcnt lgkmcnt(0)
    s_barrier
    v_pk_fma_f32 v[156:157], v[80:81], v[36:37], v[156:157] op_sel_hi:[1,0,1]
    v_pk_fma_f32 v[158:159], v[82:83], v[36:37], v[158:159] op_sel_hi:[1,0,1]
    v_pk_fma_f32 v[160:161], v[84:85], v[36:37], v[160:161] op_sel_hi:[1,0,1]
    v_pk_fma_f32 v[162:163], v[86:87], v[36:37], v[162:163] op_sel_hi:[1,0,1]
    v_pk_fma_f32 v[164:165], v[88:89], v[36:37], v[164:165] op_sel_hi:[1,0,1]
    v_pk_fma_f32 v[166:167], v[90:91], v[36:37], v[166:167] op_sel_hi:[1,0,1]
    v_pk_fma_f32 v[168:169], v[92:93], v[36:37], v[168:169] op_sel_hi:[1,0,1]
    v_pk_fma_f32 v[170:171], v[94:95], v[36:37], v[170:171] op_sel_hi:[1,0,1]
    v_pk_mul_f32 v[16:17], v[156:157], v[156:157]
    v_pk_mul_f32 v[18:19], v[158:159], v[158:159]
    v_pk_mul_f32 v[20:21], v[160:161], v[160:161]
    v_pk_mul_f32 v[22:23], v[162:163], v[162:163]
    v_pk_mul_f32 v[24:25], v[164:165], v[164:165]
    v_pk_mul_f32 v[26:27], v[166:167], v[166:167]
    v_pk_mul_f32 v[28:29], v[168:169], v[168:169]
    v_pk_mul_f32 v[30:31], v[170:171], v[170:171]
    v_pk_fma_f32 v[16:17], v[16:17], v[38:39], v[36:37] op_sel:[0,0,1] op_sel_hi:[1,0,1]
    v_pk_fma_f32 v[18:19], v[18:19], v[38:39], v[36:37] op_sel:[0,0,1] op_sel_hi:[1,0,1]
    v_pk_fma_f32 v[20:21], v[20:21], v[38:39], v[36:37] op_sel:[0,0,1] op_sel_hi:[1,0,1]
    v_pk_fma_f32 v[22:23], v[22:23], v[38:39], v[36:37] op_sel:[0,0,1] op_sel_hi:[1,0,1]
    v_pk_fma_f32 v[24:25], v[24:25], v[38:39], v[36:37] op_sel:[0,0,1] op_sel_hi:[1,0,1]
    v_pk_fma_f32 v[26:27], v[26:27], v[38:39], v[36:37] op_sel:[0,0,1] op_sel_hi:[1,0,1]
    v_pk_fma_f32 v[28:29], v[28:29], v[38:39], v[36:37] op_sel:[0,0,1] op_sel_hi:[1,0,1]
    v_pk_fma_f32 v[30:31], v[30:31], v[38:39], v[36:37] op_sel:[0,0,1] op_sel_hi:[1,0,1]
    v_pk_mul_f32 v[16:17], v[16:17], v[156:157]
    v_pk_mul_f32 v[18:19], v[18:19], v[158:159]
    v_pk_mul_f32 v[20:21], v[20:21], v[160:161]
    v_pk_mul_f32 v[22:23], v[22:23], v[162:163]
    v_pk_mul_f32 v[24:25], v[24:25], v[164:165]
    v_pk_mul_f32 v[26:27], v[26:27], v[166:167]
    v_pk_mul_f32 v[28:29], v[28:29], v[168:169]
    v_pk_mul_f32 v[30:31], v[30:31], v[170:171]
    v_exp_f32 v16, v16
    v_exp_f32 v17, v17
    v_exp_f32 v18, v18
    v_exp_f32 v19, v19
    v_exp_f32 v20, v20
    v_exp_f32 v21, v21
    v_exp_f32 v22, v22
    v_exp_f32 v23, v23
    v_exp_f32 v24, v24
    v_exp_f32 v25, v25
    v_exp_f32 v26, v26
    v_exp_f32 v27, v27
    v_exp_f32 v28, v28
    v_exp_f32 v29, v29
    v_exp_f32 v30, v30
    v_exp_f32 v31, v31
    v_pk_fma_f32 v[16:17], v[16:17], v[38:39], v[38:39] op_sel:[0,1,1] op_sel_hi:[1,1,1]
    v_pk_fma_f32 v[18:19], v[18:19], v[38:39], v[38:39] op_sel:[0,1,1] op_sel_hi:[1,1,1]
    v_pk_fma_f32 v[20:21], v[20:21], v[38:39], v[38:39] op_sel:[0,1,1] op_sel_hi:[1,1,1]
    v_pk_fma_f32 v[22:23], v[22:23], v[38:39], v[38:39] op_sel:[0,1,1] op_sel_hi:[1,1,1]
    v_pk_fma_f32 v[24:25], v[24:25], v[38:39], v[38:39] op_sel:[0,1,1] op_sel_hi:[1,1,1]
    v_pk_fma_f32 v[26:27], v[26:27], v[38:39], v[38:39] op_sel:[0,1,1] op_sel_hi:[1,1,1]
    v_pk_fma_f32 v[28:29], v[28:29], v[38:39], v[38:39] op_sel:[0,1,1] op_sel_hi:[1,1,1]
    v_pk_fma_f32 v[30:31], v[30:31], v[38:39], v[38:39] op_sel:[0,1,1] op_sel_hi:[1,1,1]
    v_rcp_f32 v16, v16
    v_rcp_f32 v17, v17
    v_rcp_f32 v18, v18
    v_rcp_f32 v19, v19
    v_rcp_f32 v20, v20
    v_rcp_f32 v21, v21
    v_rcp_f32 v22, v22
    v_rcp_f32 v23, v23
    v_rcp_f32 v24, v24
    v_rcp_f32 v25, v25
    v_rcp_f32 v26, v26
    v_rcp_f32 v27, v27
    v_rcp_f32 v28, v28
    v_rcp_f32 v29, v29
    v_rcp_f32 v30, v30
    v_rcp_f32 v31, v31
    v_pk_mul_f32 v[156:157], v[156:157], v[16:17]
    v_pk_mul_f32 v[158:159], v[158:159], v[18:19]
    v_pk_mul_f32 v[160:161], v[160:161], v[20:21]
    v_pk_mul_f32 v[162:163], v[162:163], v[22:23]
    v_pk_mul_f32 v[164:165], v[164:165], v[24:25]
    v_pk_mul_f32 v[166:167], v[166:167], v[26:27]
    v_pk_mul_f32 v[168:169], v[168:169], v[28:29]
    v_pk_mul_f32 v[170:171], v[170:171], v[30:31]
    v_cvt_pk_bf16_f32 v156, v156, v157
    v_cvt_pk_bf16_f32 v157, v158, v159
    v_cvt_pk_bf16_f32 v160, v160, v161
    v_cvt_pk_bf16_f32 v161, v162, v163
    v_cvt_pk_bf16_f32 v164, v164, v165
    v_cvt_pk_bf16_f32 v165, v166, v167
    v_cvt_pk_bf16_f32 v168, v168, v169
    v_cvt_pk_bf16_f32 v169, v170, v171
    ds_write_b64 v5, v[156:157] offset:7424
    ds_write_b64 v5, v[160:161] offset:7456
    ds_write_b64 v5, v[164:165] offset:7488
    ds_write_b64 v5, v[168:169] offset:7520
    v_pk_fma_f32 v[172:173], v[96:97], v[36:37], v[172:173] op_sel_hi:[1,0,1]
    v_pk_fma_f32 v[174:175], v[98:99], v[36:37], v[174:175] op_sel_hi:[1,0,1]
    v_pk_fma_f32 v[176:177], v[100:101], v[36:37], v[176:177] op_sel_hi:[1,0,1]
    v_pk_fma_f32 v[178:179], v[102:103], v[36:37], v[178:179] op_sel_hi:[1,0,1]
    v_pk_fma_f32 v[180:181], v[104:105], v[36:37], v[180:181] op_sel_hi:[1,0,1]
    v_pk_fma_f32 v[182:183], v[106:107], v[36:37], v[182:183] op_sel_hi:[1,0,1]
    v_pk_mul_f32 v[16:17], v[172:173], v[172:173]
    v_pk_mul_f32 v[18:19], v[174:175], v[174:175]
    v_pk_mul_f32 v[20:21], v[176:177], v[176:177]
    v_pk_mul_f32 v[22:23], v[178:179], v[178:179]
    v_pk_mul_f32 v[24:25], v[180:181], v[180:181]
    v_pk_mul_f32 v[26:27], v[182:183], v[182:183]
    v_pk_fma_f32 v[16:17], v[16:17], v[38:39], v[36:37] op_sel:[0,0,1] op_sel_hi:[1,0,1]
    v_pk_fma_f32 v[18:19], v[18:19], v[38:39], v[36:37] op_sel:[0,0,1] op_sel_hi:[1,0,1]
    v_pk_fma_f32 v[20:21], v[20:21], v[38:39], v[36:37] op_sel:[0,0,1] op_sel_hi:[1,0,1]
    v_pk_fma_f32 v[22:23], v[22:23], v[38:39], v[36:37] op_sel:[0,0,1] op_sel_hi:[1,0,1]
    v_pk_fma_f32 v[24:25], v[24:25], v[38:39], v[36:37] op_sel:[0,0,1] op_sel_hi:[1,0,1]
    v_pk_fma_f32 v[26:27], v[26:27], v[38:39], v[36:37] op_sel:[0,0,1] op_sel_hi:[1,0,1]
    v_pk_mul_f32 v[16:17], v[16:17], v[172:173]
    v_pk_mul_f32 v[18:19], v[18:19], v[174:175]
    v_pk_mul_f32 v[20:21], v[20:21], v[176:177]
    v_pk_mul_f32 v[22:23], v[22:23], v[178:179]
    v_pk_mul_f32 v[24:25], v[24:25], v[180:181]
    v_pk_mul_f32 v[26:27], v[26:27], v[182:183]
    v_exp_f32 v16, v16
    v_exp_f32 v17, v17
    v_exp_f32 v18, v18
    v_exp_f32 v19, v19
    v_exp_f32 v20, v20
    v_exp_f32 v21, v21
    v_exp_f32 v22, v22
    v_exp_f32 v23, v23
    v_exp_f32 v24, v24
    v_exp_f32 v25, v25
    v_exp_f32 v26, v26
    v_exp_f32 v27, v27
    v_pk_fma_f32 v[16:17], v[16:17], v[38:39], v[38:39] op_sel:[0,1,1] op_sel_hi:[1,1,1]
    v_pk_fma_f32 v[18:19], v[18:19], v[38:39], v[38:39] op_sel:[0,1,1] op_sel_hi:[1,1,1]
    v_pk_fma_f32 v[20:21], v[20:21], v[38:39], v[38:39] op_sel:[0,1,1] op_sel_hi:[1,1,1]
    v_pk_fma_f32 v[22:23], v[22:23], v[38:39], v[38:39] op_sel:[0,1,1] op_sel_hi:[1,1,1]
    v_pk_fma_f32 v[24:25], v[24:25], v[38:39], v[38:39] op_sel:[0,1,1] op_sel_hi:[1,1,1]
    v_pk_fma_f32 v[26:27], v[26:27], v[38:39], v[38:39] op_sel:[0,1,1] op_sel_hi:[1,1,1]
    v_rcp_f32 v16, v16
    v_rcp_f32 v17, v17
    v_rcp_f32 v18, v18
    v_rcp_f32 v19, v19
    v_rcp_f32 v20, v20
    v_rcp_f32 v21, v21
    v_rcp_f32 v22, v22
    v_rcp_f32 v23, v23
    v_rcp_f32 v24, v24
    v_rcp_f32 v25, v25
    v_rcp_f32 v26, v26
    v_rcp_f32 v27, v27
    v_pk_mul_f32 v[172:173], v[172:173], v[16:17]
    v_pk_mul_f32 v[174:175], v[174:175], v[18:19]
    v_pk_mul_f32 v[176:177], v[176:177], v[20:21]
    v_pk_mul_f32 v[178:179], v[178:179], v[22:23]
    v_pk_mul_f32 v[180:181], v[180:181], v[24:25]
    v_pk_mul_f32 v[182:183], v[182:183], v[26:27]
    v_cvt_pk_bf16_f32 v172, v172, v173
    v_cvt_pk_bf16_f32 v173, v174, v175
    v_cvt_pk_bf16_f32 v176, v176, v177
    v_cvt_pk_bf16_f32 v177, v178, v179
    v_cvt_pk_bf16_f32 v180, v180, v181
    v_cvt_pk_bf16_f32 v181, v182, v183
    ds_write_b64 v5, v[172:173] offset:7552
    ds_write_b64 v5, v[176:177] offset:7584
    ds_write_b64 v5, v[180:181] offset:7616
    s_waitcnt lgkmcnt(0)
    s_barrier
    v_pk_fma_f32 v[184:185], v[80:81], v[40:41], v[184:185] op_sel_hi:[1,0,1]
    v_pk_fma_f32 v[186:187], v[82:83], v[40:41], v[186:187] op_sel_hi:[1,0,1]
    v_pk_fma_f32 v[188:189], v[84:85], v[40:41], v[188:189] op_sel_hi:[1,0,1]
    v_pk_fma_f32 v[190:191], v[86:87], v[40:41], v[190:191] op_sel_hi:[1,0,1]
    v_pk_fma_f32 v[192:193], v[88:89], v[40:41], v[192:193] op_sel_hi:[1,0,1]
    v_pk_fma_f32 v[194:195], v[90:91], v[40:41], v[194:195] op_sel_hi:[1,0,1]
    v_pk_fma_f32 v[196:197], v[92:93], v[40:41], v[196:197] op_sel_hi:[1,0,1]
    v_pk_fma_f32 v[198:199], v[94:95], v[40:41], v[198:199] op_sel_hi:[1,0,1]
    v_pk_mul_f32 v[16:17], v[184:185], v[184:185]
    v_pk_mul_f32 v[18:19], v[186:187], v[186:187]
    v_pk_mul_f32 v[20:21], v[188:189], v[188:189]
    v_pk_mul_f32 v[22:23], v[190:191], v[190:191]
    v_pk_mul_f32 v[24:25], v[192:193], v[192:193]
    v_pk_mul_f32 v[26:27], v[194:195], v[194:195]
    v_pk_mul_f32 v[28:29], v[196:197], v[196:197]
    v_pk_mul_f32 v[30:31], v[198:199], v[198:199]
    v_pk_fma_f32 v[16:17], v[16:17], v[42:43], v[40:41] op_sel:[0,0,1] op_sel_hi:[1,0,1]
    v_pk_fma_f32 v[18:19], v[18:19], v[42:43], v[40:41] op_sel:[0,0,1] op_sel_hi:[1,0,1]
    v_pk_fma_f32 v[20:21], v[20:21], v[42:43], v[40:41] op_sel:[0,0,1] op_sel_hi:[1,0,1]
    v_pk_fma_f32 v[22:23], v[22:23], v[42:43], v[40:41] op_sel:[0,0,1] op_sel_hi:[1,0,1]
    v_pk_fma_f32 v[24:25], v[24:25], v[42:43], v[40:41] op_sel:[0,0,1] op_sel_hi:[1,0,1]
    v_pk_fma_f32 v[26:27], v[26:27], v[42:43], v[40:41] op_sel:[0,0,1] op_sel_hi:[1,0,1]
    v_pk_fma_f32 v[28:29], v[28:29], v[42:43], v[40:41] op_sel:[0,0,1] op_sel_hi:[1,0,1]
    v_pk_fma_f32 v[30:31], v[30:31], v[42:43], v[40:41] op_sel:[0,0,1] op_sel_hi:[1,0,1]
    v_pk_mul_f32 v[16:17], v[16:17], v[184:185]
    v_pk_mul_f32 v[18:19], v[18:19], v[186:187]
    v_pk_mul_f32 v[20:21], v[20:21], v[188:189]
    v_pk_mul_f32 v[22:23], v[22:23], v[190:191]
    v_pk_mul_f32 v[24:25], v[24:25], v[192:193]
    v_pk_mul_f32 v[26:27], v[26:27], v[194:195]
    v_pk_mul_f32 v[28:29], v[28:29], v[196:197]
    v_pk_mul_f32 v[30:31], v[30:31], v[198:199]
    v_exp_f32 v16, v16
    v_exp_f32 v17, v17
    v_exp_f32 v18, v18
    v_exp_f32 v19, v19
    v_exp_f32 v20, v20
    v_exp_f32 v21, v21
    v_exp_f32 v22, v22
    v_exp_f32 v23, v23
    v_exp_f32 v24, v24
    v_exp_f32 v25, v25
    v_exp_f32 v26, v26
    v_exp_f32 v27, v27
    v_exp_f32 v28, v28
    v_exp_f32 v29, v29
    v_exp_f32 v30, v30
    v_exp_f32 v31, v31
    v_pk_fma_f32 v[16:17], v[16:17], v[42:43], v[42:43] op_sel:[0,1,1] op_sel_hi:[1,1,1]
    v_pk_fma_f32 v[18:19], v[18:19], v[42:43], v[42:43] op_sel:[0,1,1] op_sel_hi:[1,1,1]
    v_pk_fma_f32 v[20:21], v[20:21], v[42:43], v[42:43] op_sel:[0,1,1] op_sel_hi:[1,1,1]
    v_pk_fma_f32 v[22:23], v[22:23], v[42:43], v[42:43] op_sel:[0,1,1] op_sel_hi:[1,1,1]
    v_pk_fma_f32 v[24:25], v[24:25], v[42:43], v[42:43] op_sel:[0,1,1] op_sel_hi:[1,1,1]
    v_pk_fma_f32 v[26:27], v[26:27], v[42:43], v[42:43] op_sel:[0,1,1] op_sel_hi:[1,1,1]
    v_pk_fma_f32 v[28:29], v[28:29], v[42:43], v[42:43] op_sel:[0,1,1] op_sel_hi:[1,1,1]
    v_pk_fma_f32 v[30:31], v[30:31], v[42:43], v[42:43] op_sel:[0,1,1] op_sel_hi:[1,1,1]
    v_rcp_f32 v16, v16
    v_rcp_f32 v17, v17
    v_rcp_f32 v18, v18
    v_rcp_f32 v19, v19
    v_rcp_f32 v20, v20
    v_rcp_f32 v21, v21
    v_rcp_f32 v22, v22
    v_rcp_f32 v23, v23
    v_rcp_f32 v24, v24
    v_rcp_f32 v25, v25
    v_rcp_f32 v26, v26
    v_rcp_f32 v27, v27
    v_rcp_f32 v28, v28
    v_rcp_f32 v29, v29
    v_rcp_f32 v30, v30
    v_rcp_f32 v31, v31
    v_pk_mul_f32 v[184:185], v[184:185], v[16:17]
    v_pk_mul_f32 v[186:187], v[186:187], v[18:19]
    v_pk_mul_f32 v[188:189], v[188:189], v[20:21]
    v_pk_mul_f32 v[190:191], v[190:191], v[22:23]
    v_pk_mul_f32 v[192:193], v[192:193], v[24:25]
    v_pk_mul_f32 v[194:195], v[194:195], v[26:27]
    v_pk_mul_f32 v[196:197], v[196:197], v[28:29]
    v_pk_mul_f32 v[198:199], v[198:199], v[30:31]
    v_cvt_pk_bf16_f32 v184, v184, v185
    v_cvt_pk_bf16_f32 v185, v186, v187
    v_cvt_pk_bf16_f32 v188, v188, v189
    v_cvt_pk_bf16_f32 v189, v190, v191
    v_cvt_pk_bf16_f32 v192, v192, v193
    v_cvt_pk_bf16_f32 v193, v194, v195
    v_cvt_pk_bf16_f32 v196, v196, v197
    v_cvt_pk_bf16_f32 v197, v198, v199
    ds_write_b64 v5, v[184:185] offset:14848
    ds_write_b64 v5, v[188:189] offset:14880
    ds_write_b64 v5, v[192:193] offset:14912
    ds_write_b64 v5, v[196:197] offset:14944
    v_pk_fma_f32 v[200:201], v[96:97], v[40:41], v[200:201] op_sel_hi:[1,0,1]
    v_pk_fma_f32 v[202:203], v[98:99], v[40:41], v[202:203] op_sel_hi:[1,0,1]
    v_pk_fma_f32 v[204:205], v[100:101], v[40:41], v[204:205] op_sel_hi:[1,0,1]
    v_pk_fma_f32 v[206:207], v[102:103], v[40:41], v[206:207] op_sel_hi:[1,0,1]
    v_pk_fma_f32 v[208:209], v[104:105], v[40:41], v[208:209] op_sel_hi:[1,0,1]
    v_pk_fma_f32 v[210:211], v[106:107], v[40:41], v[210:211] op_sel_hi:[1,0,1]
    v_pk_mul_f32 v[16:17], v[200:201], v[200:201]
    v_pk_mul_f32 v[18:19], v[202:203], v[202:203]
    v_pk_mul_f32 v[20:21], v[204:205], v[204:205]
    v_pk_mul_f32 v[22:23], v[206:207], v[206:207]
    v_pk_mul_f32 v[24:25], v[208:209], v[208:209]
    v_pk_mul_f32 v[26:27], v[210:211], v[210:211]
    v_pk_fma_f32 v[16:17], v[16:17], v[42:43], v[40:41] op_sel:[0,0,1] op_sel_hi:[1,0,1]
    v_pk_fma_f32 v[18:19], v[18:19], v[42:43], v[40:41] op_sel:[0,0,1] op_sel_hi:[1,0,1]
    v_pk_fma_f32 v[20:21], v[20:21], v[42:43], v[40:41] op_sel:[0,0,1] op_sel_hi:[1,0,1]
    v_pk_fma_f32 v[22:23], v[22:23], v[42:43], v[40:41] op_sel:[0,0,1] op_sel_hi:[1,0,1]
    v_pk_fma_f32 v[24:25], v[24:25], v[42:43], v[40:41] op_sel:[0,0,1] op_sel_hi:[1,0,1]
    v_pk_fma_f32 v[26:27], v[26:27], v[42:43], v[40:41] op_sel:[0,0,1] op_sel_hi:[1,0,1]
    v_pk_mul_f32 v[16:17], v[16:17], v[200:201]
    v_pk_mul_f32 v[18:19], v[18:19], v[202:203]
    v_pk_mul_f32 v[20:21], v[20:21], v[204:205]
    v_pk_mul_f32 v[22:23], v[22:23], v[206:207]
    v_pk_mul_f32 v[24:25], v[24:25], v[208:209]
    v_pk_mul_f32 v[26:27], v[26:27], v[210:211]
    v_exp_f32 v16, v16
    v_exp_f32 v17, v17
    v_exp_f32 v18, v18
    v_exp_f32 v19, v19
    v_exp_f32 v20, v20
    v_exp_f32 v21, v21
    v_exp_f32 v22, v22
    v_exp_f32 v23, v23
    v_exp_f32 v24, v24
    v_exp_f32 v25, v25
    v_exp_f32 v26, v26
    v_exp_f32 v27, v27
    v_pk_fma_f32 v[16:17], v[16:17], v[42:43], v[42:43] op_sel:[0,1,1] op_sel_hi:[1,1,1]
    v_pk_fma_f32 v[18:19], v[18:19], v[42:43], v[42:43] op_sel:[0,1,1] op_sel_hi:[1,1,1]
    v_pk_fma_f32 v[20:21], v[20:21], v[42:43], v[42:43] op_sel:[0,1,1] op_sel_hi:[1,1,1]
    v_pk_fma_f32 v[22:23], v[22:23], v[42:43], v[42:43] op_sel:[0,1,1] op_sel_hi:[1,1,1]
    v_pk_fma_f32 v[24:25], v[24:25], v[42:43], v[42:43] op_sel:[0,1,1] op_sel_hi:[1,1,1]
    v_pk_fma_f32 v[26:27], v[26:27], v[42:43], v[42:43] op_sel:[0,1,1] op_sel_hi:[1,1,1]
    v_rcp_f32 v16, v16
    v_rcp_f32 v17, v17
    v_rcp_f32 v18, v18
    v_rcp_f32 v19, v19
    v_rcp_f32 v20, v20
    v_rcp_f32 v21, v21
    v_rcp_f32 v22, v22
    v_rcp_f32 v23, v23
    v_rcp_f32 v24, v24
    v_rcp_f32 v25, v25
    v_rcp_f32 v26, v26
    v_rcp_f32 v27, v27
    v_pk_mul_f32 v[200:201], v[200:201], v[16:17]
    v_pk_mul_f32 v[202:203], v[202:203], v[18:19]
    v_pk_mul_f32 v[204:205], v[204:205], v[20:21]
    v_pk_mul_f32 v[206:207], v[206:207], v[22:23]
    v_pk_mul_f32 v[208:209], v[208:209], v[24:25]
    v_pk_mul_f32 v[210:211], v[210:211], v[26:27]
    v_cvt_pk_bf16_f32 v200, v200, v201
    v_cvt_pk_bf16_f32 v201, v202, v203
    v_cvt_pk_bf16_f32 v204, v204, v205
    v_cvt_pk_bf16_f32 v205, v206, v207
    v_cvt_pk_bf16_f32 v208, v208, v209
    v_cvt_pk_bf16_f32 v209, v210, v211
    ds_write_b64 v5, v[200:201] offset:14976
    ds_write_b64 v5, v[204:205] offset:15008
    ds_write_b64 v5, v[208:209] offset:15040
    s_waitcnt lgkmcnt(0)
    s_barrier
    v_pk_fma_f32 v[212:213], v[80:81], v[44:45], v[212:213] op_sel_hi:[1,0,1]
    v_pk_fma_f32 v[214:215], v[82:83], v[44:45], v[214:215] op_sel_hi:[1,0,1]
    v_pk_fma_f32 v[216:217], v[84:85], v[44:45], v[216:217] op_sel_hi:[1,0,1]
    v_pk_fma_f32 v[218:219], v[86:87], v[44:45], v[218:219] op_sel_hi:[1,0,1]
    v_pk_fma_f32 v[220:221], v[88:89], v[44:45], v[220:221] op_sel_hi:[1,0,1]
    v_pk_fma_f32 v[222:223], v[90:91], v[44:45], v[222:223] op_sel_hi:[1,0,1]
    v_pk_fma_f32 v[224:225], v[92:93], v[44:45], v[224:225] op_sel_hi:[1,0,1]
    v_pk_fma_f32 v[226:227], v[94:95], v[44:45], v[226:227] op_sel_hi:[1,0,1]
    v_pk_mul_f32 v[16:17], v[212:213], v[212:213]
    v_pk_mul_f32 v[18:19], v[214:215], v[214:215]
    v_pk_mul_f32 v[20:21], v[216:217], v[216:217]
    v_pk_mul_f32 v[22:23], v[218:219], v[218:219]
    v_pk_mul_f32 v[24:25], v[220:221], v[220:221]
    v_pk_mul_f32 v[26:27], v[222:223], v[222:223]
    v_pk_mul_f32 v[28:29], v[224:225], v[224:225]
    v_pk_mul_f32 v[30:31], v[226:227], v[226:227]
    v_pk_fma_f32 v[16:17], v[16:17], v[46:47], v[44:45] op_sel:[0,0,1] op_sel_hi:[1,0,1]
    v_pk_fma_f32 v[18:19], v[18:19], v[46:47], v[44:45] op_sel:[0,0,1] op_sel_hi:[1,0,1]
    v_pk_fma_f32 v[20:21], v[20:21], v[46:47], v[44:45] op_sel:[0,0,1] op_sel_hi:[1,0,1]
    v_pk_fma_f32 v[22:23], v[22:23], v[46:47], v[44:45] op_sel:[0,0,1] op_sel_hi:[1,0,1]
    v_pk_fma_f32 v[24:25], v[24:25], v[46:47], v[44:45] op_sel:[0,0,1] op_sel_hi:[1,0,1]
    v_pk_fma_f32 v[26:27], v[26:27], v[46:47], v[44:45] op_sel:[0,0,1] op_sel_hi:[1,0,1]
    v_pk_fma_f32 v[28:29], v[28:29], v[46:47], v[44:45] op_sel:[0,0,1] op_sel_hi:[1,0,1]
    v_pk_fma_f32 v[30:31], v[30:31], v[46:47], v[44:45] op_sel:[0,0,1] op_sel_hi:[1,0,1]
    v_pk_mul_f32 v[16:17], v[16:17], v[212:213]
    v_pk_mul_f32 v[18:19], v[18:19], v[214:215]
    v_pk_mul_f32 v[20:21], v[20:21], v[216:217]
    v_pk_mul_f32 v[22:23], v[22:23], v[218:219]
    v_pk_mul_f32 v[24:25], v[24:25], v[220:221]
    v_pk_mul_f32 v[26:27], v[26:27], v[222:223]
    v_pk_mul_f32 v[28:29], v[28:29], v[224:225]
    v_pk_mul_f32 v[30:31], v[30:31], v[226:227]
    v_exp_f32 v16, v16
    v_exp_f32 v17, v17
    v_exp_f32 v18, v18
    v_exp_f32 v19, v19
    v_exp_f32 v20, v20
    v_exp_f32 v21, v21
    v_exp_f32 v22, v22
    v_exp_f32 v23, v23
    v_exp_f32 v24, v24
    v_exp_f32 v25, v25
    v_exp_f32 v26, v26
    v_exp_f32 v27, v27
    v_exp_f32 v28, v28
    v_exp_f32 v29, v29
    v_exp_f32 v30, v30
    v_exp_f32 v31, v31
    v_pk_fma_f32 v[16:17], v[16:17], v[46:47], v[46:47] op_sel:[0,1,1] op_sel_hi:[1,1,1]
    v_pk_fma_f32 v[18:19], v[18:19], v[46:47], v[46:47] op_sel:[0,1,1] op_sel_hi:[1,1,1]
    v_pk_fma_f32 v[20:21], v[20:21], v[46:47], v[46:47] op_sel:[0,1,1] op_sel_hi:[1,1,1]
    v_pk_fma_f32 v[22:23], v[22:23], v[46:47], v[46:47] op_sel:[0,1,1] op_sel_hi:[1,1,1]
    v_pk_fma_f32 v[24:25], v[24:25], v[46:47], v[46:47] op_sel:[0,1,1] op_sel_hi:[1,1,1]
    v_pk_fma_f32 v[26:27], v[26:27], v[46:47], v[46:47] op_sel:[0,1,1] op_sel_hi:[1,1,1]
    v_pk_fma_f32 v[28:29], v[28:29], v[46:47], v[46:47] op_sel:[0,1,1] op_sel_hi:[1,1,1]
    v_pk_fma_f32 v[30:31], v[30:31], v[46:47], v[46:47] op_sel:[0,1,1] op_sel_hi:[1,1,1]
    v_rcp_f32 v16, v16
    v_rcp_f32 v17, v17
    v_rcp_f32 v18, v18
    v_rcp_f32 v19, v19
    v_rcp_f32 v20, v20
    v_rcp_f32 v21, v21
    v_rcp_f32 v22, v22
    v_rcp_f32 v23, v23
    v_rcp_f32 v24, v24
    v_rcp_f32 v25, v25
    v_rcp_f32 v26, v26
    v_rcp_f32 v27, v27
    v_rcp_f32 v28, v28
    v_rcp_f32 v29, v29
    v_rcp_f32 v30, v30
    v_rcp_f32 v31, v31
    v_pk_mul_f32 v[212:213], v[212:213], v[16:17]
    v_pk_mul_f32 v[214:215], v[214:215], v[18:19]
    v_pk_mul_f32 v[216:217], v[216:217], v[20:21]
    v_pk_mul_f32 v[218:219], v[218:219], v[22:23]
    v_pk_mul_f32 v[220:221], v[220:221], v[24:25]
    v_pk_mul_f32 v[222:223], v[222:223], v[26:27]
    v_pk_mul_f32 v[224:225], v[224:225], v[28:29]
    v_pk_mul_f32 v[226:227], v[226:227], v[30:31]
    v_cvt_pk_bf16_f32 v212, v212, v213
    v_cvt_pk_bf16_f32 v213, v214, v215
    v_cvt_pk_bf16_f32 v216, v216, v217
    v_cvt_pk_bf16_f32 v217, v218, v219
    v_cvt_pk_bf16_f32 v220, v220, v221
    v_cvt_pk_bf16_f32 v221, v222, v223
    v_cvt_pk_bf16_f32 v224, v224, v225
    v_cvt_pk_bf16_f32 v225, v226, v227
    ds_write_b64 v5, v[212:213] offset:22272
    ds_write_b64 v5, v[216:217] offset:22304
    ds_write_b64 v5, v[220:221] offset:22336
    ds_write_b64 v5, v[224:225] offset:22368
    v_pk_fma_f32 v[228:229], v[96:97], v[44:45], v[228:229] op_sel_hi:[1,0,1]
    v_pk_fma_f32 v[230:231], v[98:99], v[44:45], v[230:231] op_sel_hi:[1,0,1]
    v_pk_fma_f32 v[232:233], v[100:101], v[44:45], v[232:233] op_sel_hi:[1,0,1]
    v_pk_fma_f32 v[234:235], v[102:103], v[44:45], v[234:235] op_sel_hi:[1,0,1]
    v_pk_fma_f32 v[236:237], v[104:105], v[44:45], v[236:237] op_sel_hi:[1,0,1]
    v_pk_fma_f32 v[238:239], v[106:107], v[44:45], v[238:239] op_sel_hi:[1,0,1]
    v_pk_mul_f32 v[16:17], v[228:229], v[228:229]
    v_pk_mul_f32 v[18:19], v[230:231], v[230:231]
    v_pk_mul_f32 v[20:21], v[232:233], v[232:233]
    v_pk_mul_f32 v[22:23], v[234:235], v[234:235]
    v_pk_mul_f32 v[24:25], v[236:237], v[236:237]
    v_pk_mul_f32 v[26:27], v[238:239], v[238:239]
    v_pk_fma_f32 v[16:17], v[16:17], v[46:47], v[44:45] op_sel:[0,0,1] op_sel_hi:[1,0,1]
    v_pk_fma_f32 v[18:19], v[18:19], v[46:47], v[44:45] op_sel:[0,0,1] op_sel_hi:[1,0,1]
    v_pk_fma_f32 v[20:21], v[20:21], v[46:47], v[44:45] op_sel:[0,0,1] op_sel_hi:[1,0,1]
    v_pk_fma_f32 v[22:23], v[22:23], v[46:47], v[44:45] op_sel:[0,0,1] op_sel_hi:[1,0,1]
    v_pk_fma_f32 v[24:25], v[24:25], v[46:47], v[44:45] op_sel:[0,0,1] op_sel_hi:[1,0,1]
    v_pk_fma_f32 v[26:27], v[26:27], v[46:47], v[44:45] op_sel:[0,0,1] op_sel_hi:[1,0,1]
    v_pk_mul_f32 v[16:17], v[16:17], v[228:229]
    v_pk_mul_f32 v[18:19], v[18:19], v[230:231]
    v_pk_mul_f32 v[20:21], v[20:21], v[232:233]
    v_pk_mul_f32 v[22:23], v[22:23], v[234:235]
    v_pk_mul_f32 v[24:25], v[24:25], v[236:237]
    v_pk_mul_f32 v[26:27], v[26:27], v[238:239]
    v_exp_f32 v16, v16
    v_exp_f32 v17, v17
    v_exp_f32 v18, v18
    v_exp_f32 v19, v19
    v_exp_f32 v20, v20
    v_exp_f32 v21, v21
    v_exp_f32 v22, v22
    v_exp_f32 v23, v23
    v_exp_f32 v24, v24
    v_exp_f32 v25, v25
    v_exp_f32 v26, v26
    v_exp_f32 v27, v27
    v_pk_fma_f32 v[16:17], v[16:17], v[46:47], v[46:47] op_sel:[0,1,1] op_sel_hi:[1,1,1]
    v_pk_fma_f32 v[18:19], v[18:19], v[46:47], v[46:47] op_sel:[0,1,1] op_sel_hi:[1,1,1]
    v_pk_fma_f32 v[20:21], v[20:21], v[46:47], v[46:47] op_sel:[0,1,1] op_sel_hi:[1,1,1]
    v_pk_fma_f32 v[22:23], v[22:23], v[46:47], v[46:47] op_sel:[0,1,1] op_sel_hi:[1,1,1]
    v_pk_fma_f32 v[24:25], v[24:25], v[46:47], v[46:47] op_sel:[0,1,1] op_sel_hi:[1,1,1]
    v_pk_fma_f32 v[26:27], v[26:27], v[46:47], v[46:47] op_sel:[0,1,1] op_sel_hi:[1,1,1]
    v_rcp_f32 v16, v16
    v_rcp_f32 v17, v17
    v_rcp_f32 v18, v18
    v_rcp_f32 v19, v19
    v_rcp_f32 v20, v20
    v_rcp_f32 v21, v21
    v_rcp_f32 v22, v22
    v_rcp_f32 v23, v23
    v_rcp_f32 v24, v24
    v_rcp_f32 v25, v25
    v_rcp_f32 v26, v26
    v_rcp_f32 v27, v27
    v_pk_mul_f32 v[228:229], v[228:229], v[16:17]
    v_pk_mul_f32 v[230:231], v[230:231], v[18:19]
    v_pk_mul_f32 v[232:233], v[232:233], v[20:21]
    v_pk_mul_f32 v[234:235], v[234:235], v[22:23]
    v_pk_mul_f32 v[236:237], v[236:237], v[24:25]
    v_pk_mul_f32 v[238:239], v[238:239], v[26:27]
    v_cvt_pk_bf16_f32 v228, v228, v229
    v_cvt_pk_bf16_f32 v229, v230, v231
    v_cvt_pk_bf16_f32 v232, v232, v233
    v_cvt_pk_bf16_f32 v233, v234, v235
    v_cvt_pk_bf16_f32 v236, v236, v237
    v_cvt_pk_bf16_f32 v237, v238, v239
    ds_write_b64 v5, v[228:229] offset:22400
    ds_write_b64 v5, v[232:233] offset:22432
    ds_write_b64 v5, v[236:237] offset:22464
    s_waitcnt lgkmcnt(0)
    s_barrier
    s_branch k3_kernel_finnw
k3_kernel_end:
k4_kernel:
    s_and_b32 s53, s2, 7
    s_lshr_b32 s54, s2, 3
    s_lshr_b32 s55, s53, 0
    s_and_b32 s55, s55, 1
    s_lshr_b32 s45, s53, 1
    s_and_b32 s45, s45, 1
    s_lshl_b32 s45, s45, 3
    s_lshr_b32 s46, s54, 2
    s_and_b32 s46, s46, 7
    s_add_u32 s48, s45, s46
    s_lshr_b32 s45, s53, 2
    s_and_b32 s45, s45, 1
    s_lshl_b32 s45, s45, 2
    s_lshr_b32 s46, s54, 0
    s_and_b32 s46, s46, 3
    s_add_u32 s49, s45, s46
    s_lshl_b32 s33, s48, 7
    s_mul_i32 s34, s49, 128
    v_lshrrev_b32 v1, 6, v0
    v_and_b32 v2, 63, v0
    s_nop 0
    v_readfirstlane_b32 s32, v1
    s_mov_b32 s50, 0xc0135761
    s_mov_b32 s51, 0xbdd2d3e8
    s_mov_b32 s52, 0xffff0000
    s_waitcnt lgkmcnt(0)
    s_add_u32 s8, s70, 0xa00000
    s_addc_u32 s9, s71, 0
    s_mov_b32 s10, 0xe40000
    s_mov_b32 s11, 0x20000
    s_mov_b32 s12, s64
    s_mov_b32 s13, s65
    s_mov_b32 s14, 0x700000
    s_mov_b32 s15, 0x20000
    s_cmp_lt_u32 s32, 4
    s_cbranch_scc1 k4_kernel_cons
k4_kernel_prod:
    s_sub_u32 s35, s32, 4
    v_lshrrev_b32 v3, 3, v2
    v_and_b32 v4, 7, v2
    v_lshrrev_b32 v5, 4, v2
    s_lshl_b32 s44, s35, 5
    s_add_u32 s44, s44, s33
    s_mov_b32 s45, 7296
    v_add_u32 v6, s44, v3
    v_mul_lo_u32 v6, v6, s45
    s_mul_i32 s72, s55, 3584
    s_sub_u32 s73, 3584, s72
    s_mul_i32 s74, s55, 3670016
    s_sub_u32 s75, 3670016, s74
    s_lshl_b32 s44, s55, 6
    s_lshl_b32 s46, s35, 4
    s_add_u32 s44, s44, s46
    s_lshl_b32 s5, s44, 7
    s_add_u32 s44, s44, s33
    v_add_u32 v16, s44, v3
    v_mul_lo_u32 v16, v16, s45
    v_xor_b32 v7, v4, v5
    v_xor_b32 v20, 4, v7
    v_lshl_add_u32 v17, v20, 4, v16
    v_add_u32 v17, 58368, v17
    v_lshl_add_u32 v16, v7, 4, v16
    v_xor_b32 v7, v4, v5
    v_lshl_add_u32 v8, v7, 4, v6
    v_xor_b32 v7, 4, v7
    v_lshl_add_u32 v9, v7, 4, v6
    v_add_u32 v9, 58368, v9
    v_add_u32 v10, 116736, v8
    v_add_u32 v11, 116736, v9
    s_lshl_b32 s46, s34, 1
    s_mov_b32 s45, 2048
    s_lshl_b32 s44, s35, 4
    v_add_u32 v6, s44, v5
    v_mul_lo_u32 v6, v6, s45
    v_add_u32 v6, s46, v6
    v_and_b32 v7, 15, v2
    v_lshlrev_b32 v20, 1, v5
    v_xor_b32 v7, v7, v20
    v_lshl_add_u32 v12, v7, 4, v6
    v_add_u32 v13, 8192, v12
    v_xor_b32 v7, 8, v7
    v_lshl_add_u32 v14, v7, 4, v6
    v_add_u32 v14, 16384, v14
    v_add_u32 v15, 8192, v14
    s_lshl_b32 s42, s35, 12
    s_mul_i32 s43, s35, 4096
    s_add_u32 s43, s43, 16384
    s_add_u32 s38, s72, 0x0
    s_add_u32 s39, s74, 0x0
    s_add_u32 m0, s43, 0x0
    s_nop 0
    buffer_load_dwordx4 v12, s[12:15], s39 offen lds
    s_add_u32 m0, s43, 0x400
    s_nop 0
    buffer_load_dwordx4 v13, s[12:15], s39 offen lds
    s_add_u32 m0, s43, 0x800
    s_nop 0
    buffer_load_dwordx4 v14, s[12:15], s39 offen lds
    s_add_u32 m0, s43, 0xc00
    s_nop 0
    buffer_load_dwordx4 v15, s[12:15], s39 offen lds
    s_add_u32 s38, s72, 0x80
    s_add_u32 s39, s74, 0x20000
    s_add_u32 m0, s43, 0x8000
    s_nop 0
    buffer_load_dwordx4 v12, s[12:15], s39 offen lds
    s_add_u32 m0, s43, 0x8400
    s_nop 0
    buffer_load_dwordx4 v13, s[12:15], s39 offen lds
    s_add_u32 m0, s43, 0x8800
    s_nop 0
    buffer_load_dwordx4 v14, s[12:15], s39 offen lds
    s_add_u32 m0, s43, 0x8c00
    s_nop 0
    buffer_load_dwordx4 v15, s[12:15], s39 offen lds
    s_add_u32 s38, s72, 0x100
    s_add_u32 s39, s74, 0x40000
    s_add_u32 m0, s43, 0x10000
    s_nop 0
    buffer_load_dwordx4 v12, s[12:15], s39 offen lds
    s_add_u32 m0, s43, 0x10400
    s_nop 0
    buffer_load_dwordx4 v13, s[12:15], s39 offen lds
    s_add_u32 m0, s43, 0x10800
    s_nop 0
    buffer_load_dwordx4 v14, s[12:15], s39 offen lds
    s_add_u32 m0, s43, 0x10c00
    s_nop 0
    buffer_load_dwordx4 v15, s[12:15], s39 offen lds
    s_add_u32 s38, s72, 0x180
    s_add_u32 s39, s74, 0x60000
    s_add_u32 m0, s43, 0x18000
    s_nop 0
    buffer_load_dwordx4 v12, s[12:15], s39 offen lds
    s_add_u32 m0, s43, 0x18400
    s_nop 0
    buffer_load_dwordx4 v13, s[12:15], s39 offen lds
    s_add_u32 m0, s43, 0x18800
    s_nop 0
    buffer_load_dwordx4 v14, s[12:15], s39 offen lds
    s_add_u32 m0, s43, 0x18c00
    s_nop 0
    buffer_load_dwordx4 v15, s[12:15], s39 offen lds
    s_cmp_lg_u32 s35, 0
    s_cbranch_scc1 k4_kernel_dok
    s_add_u32 s20, s70, 0x1b21000
    s_addc_u32 s21, s71, 0
    s_mov_b32 s22, 0x800
    s_mov_b32 s23, 0x20000
    v_and_b32 v26, 15, v2
    v_lshrrev_b32 v27, 4, v2
    v_mov_b32 v27, s48
    v_lshl_add_u32 v26, v27, 4, v26
    v_lshlrev_b32 v26, 3, v26
k4_kernel_dpoll:
    buffer_load_dwordx2 v[24:25], v26, s[20:23], 0 offen sc1
    s_waitcnt vmcnt(0)
    v_xor_b32 v24, s6, v24
    v_xor_b32 v25, s7, v25
    v_or_b32 v24, v24, v25
    v_cmp_ne_u32 vcc, 0, v24
    s_nop 4
    s_cmp_eq_u64 vcc, 0
    s_cbranch_scc0 k4_kernel_dpoll
k4_kernel_dok:
    s_barrier
    s_add_u32 s38, s72, 0x0
    s_add_u32 s39, s74, 0x0
    s_add_u32 m0, s42, 0x0
    s_nop 0
    buffer_load_dwordx4 v8, s[8:11], s38 offen sc1 lds
    s_add_u32 m0, s42, 0x400
    s_nop 0
    buffer_load_dwordx4 v9, s[8:11], s38 offen sc1 lds
    s_add_u32 m0, s42, 0x800
    s_nop 0
    buffer_load_dwordx4 v10, s[8:11], s38 offen sc1 lds
    s_add_u32 m0, s42, 0xc00
    s_nop 0
    buffer_load_dwordx4 v11, s[8:11], s38 offen sc1 lds
    s_add_u32 s38, s72, 0x80
    s_add_u32 s39, s74, 0x20000
    s_add_u32 m0, s42, 0x8000
    s_nop 0
    buffer_load_dwordx4 v8, s[8:11], s38 offen sc1 lds
    s_add_u32 m0, s42, 0x8400
    s_nop 0
    buffer_load_dwordx4 v9, s[8:11], s38 offen sc1 lds
    s_add_u32 m0, s42, 0x8800
    s_nop 0
    buffer_load_dwordx4 v10, s[8:11], s38 offen sc1 lds
    s_add_u32 m0, s42, 0x8c00
    s_nop 0
    buffer_load_dwordx4 v11, s[8:11], s38 offen sc1 lds
    s_mov_b32 s20, s66
    s_mov_b32 s21, s67
    s_mov_b32 s22, 0x400000
    s_mov_b32 s23, 0x20000
    s_add_u32 s16, s70, 0x500000
    s_addc_u32 s17, s71, 0
    s_mov_b32 s18, 0x440000
    s_mov_b32 s19, 0x20000
    s_mov_b32 s24, s70
    s_mov_b32 s25, s71
    s_mov_b32 s26, 0x2800000
    s_mov_b32 s27, 0x20000
    s_mov_b32 s28, s68
    s_mov_b32 s29, s69
    s_mov_b32 s30, 0x100
    s_mov_b32 s31, 0x20000
    s_waitcnt vmcnt(4)
    s_barrier
    s_add_u32 s38, s72, 0x100
    s_add_u32 s39, s74, 0x40000
    s_add_u32 m0, s42, 0x10000
    s_nop 0
    buffer_load_dwordx4 v8, s[8:11], s38 offen sc1 lds
    s_add_u32 m0, s42, 0x10400
    s_nop 0
    buffer_load_dwordx4 v9, s[8:11], s38 offen sc1 lds
    s_add_u32 m0, s42, 0x10800
    s_nop 0
    buffer_load_dwordx4 v10, s[8:11], s38 offen sc1 lds
    s_add_u32 m0, s42, 0x10c00
    s_nop 0
    buffer_load_dwordx4 v11, s[8:11], s38 offen sc1 lds
    s_add_u32 s38, s72, 0x180
    s_add_u32 s39, s74, 0x60000
    s_add_u32 m0, s42, 0x18000
    s_nop 0
    buffer_load_dwordx4 v8, s[8:11], s38 offen sc1 lds
    s_add_u32 m0, s42, 0x18400
    s_nop 0
    buffer_load_dwordx4 v9, s[8:11], s38 offen sc1 lds
    s_add_u32 m0, s42, 0x18800
    s_nop 0
    buffer_load_dwordx4 v10, s[8:11], s38 offen sc1 lds
    s_add_u32 m0, s42, 0x18c00
    s_nop 0
    buffer_load_dwordx4 v11, s[8:11], s38 offen sc1 lds
    s_waitcnt vmcnt(8)
    s_barrier
    s_add_u32 s38, s72, 0x200
    s_add_u32 s39, s74, 0x80000
    s_add_u32 m0, s42, 0x0
    s_nop 0
    buffer_load_dwordx4 v8, s[8:11], s38 offen sc1 lds
    s_add_u32 m0, s42, 0x400
    s_nop 0
    buffer_load_dwordx4 v9, s[8:11], s38 offen sc1 lds
    s_add_u32 m0, s42, 0x800
    s_nop 0
    buffer_load_dwordx4 v10, s[8:11], s38 offen sc1 lds
    s_add_u32 m0, s42, 0xc00
    s_nop 0
    buffer_load_dwordx4 v11, s[8:11], s38 offen sc1 lds
    s_add_u32 m0, s43, 0x0
    s_nop 0
    buffer_load_dwordx4 v12, s[12:15], s39 offen lds
    s_add_u32 m0, s43, 0x400
    s_nop 0
    buffer_load_dwordx4 v13, s[12:15], s39 offen lds
    s_add_u32 m0, s43, 0x800
    s_nop 0
    buffer_load_dwordx4 v14, s[12:15], s39 offen lds
    s_add_u32 m0, s43, 0xc00
    s_nop 0
    buffer_load_dwordx4 v15, s[12:15], s39 offen lds
    s_waitcnt vmcnt(12)
    s_barrier
    s_add_u32 s38, s72, 0x280
    s_add_u32 s39, s74, 0xa0000
    s_add_u32 m0, s42, 0x8000
    s_nop 0
    buffer_load_dwordx4 v8, s[8:11], s38 offen sc1 lds
    s_add_u32 m0, s42, 0x8400
    s_nop 0
    buffer_load_dwordx4 v9, s[8:11], s38 offen sc1 lds
    s_add_u32 m0, s42, 0x8800
    s_nop 0
    buffer_load_dwordx4 v10, s[8:11], s38 offen sc1 lds
    s_add_u32 m0, s42, 0x8c00
    s_nop 0
    buffer_load_dwordx4 v11, s[8:11], s38 offen sc1 lds
    s_add_u32 m0, s43, 0x8000
    s_nop 0
    buffer_load_dwordx4 v12, s[12:15], s39 offen lds
    s_add_u32 m0, s43, 0x8400
    s_nop 0
    buffer_load_dwordx4 v13, s[12:15], s39 offen lds
    s_add_u32 m0, s43, 0x8800
    s_nop 0
    buffer_load_dwordx4 v14, s[12:15], s39 offen lds
    s_add_u32 m0, s43, 0x8c00
    s_nop 0
    buffer_load_dwordx4 v15, s[12:15], s39 offen lds
    s_waitcnt vmcnt(16)
    s_barrier
    s_add_u32 s38, s72, 0x300
    s_add_u32 s39, s74, 0xc0000
    s_add_u32 m0, s42, 0x10000
    s_nop 0
    buffer_load_dwordx4 v8, s[8:11], s38 offen sc1 lds
    s_add_u32 m0, s42, 0x10400
    s_nop 0
    buffer_load_dwordx4 v9, s[8:11], s38 offen sc1 lds
    s_add_u32 m0, s42, 0x10800
    s_nop 0
    buffer_load_dwordx4 v10, s[8:11], s38 offen sc1 lds
    s_add_u32 m0, s42, 0x10c00
    s_nop 0
    buffer_load_dwordx4 v11, s[8:11], s38 offen sc1 lds
    s_add_u32 m0, s43, 0x10000
    s_nop 0
    buffer_load_dwordx4 v12, s[12:15], s39 offen lds
    s_add_u32 m0, s43, 0x10400
    s_nop 0
    buffer_load_dwordx4 v13, s[12:15], s39 offen lds
    s_add_u32 m0, s43, 0x10800
    s_nop 0
    buffer_load_dwordx4 v14, s[12:15], s39 offen lds
    s_add_u32 m0, s43, 0x10c00
    s_nop 0
    buffer_load_dwordx4 v15, s[12:15], s39 offen lds
    s_waitcnt vmcnt(16)
    s_barrier
    s_add_u32 s38, s72, 0x380
    s_add_u32 s39, s74, 0xe0000
    s_add_u32 m0, s42, 0x18000
    s_nop 0
    buffer_load_dwordx4 v8, s[8:11], s38 offen sc1 lds
    s_add_u32 m0, s42, 0x18400
    s_nop 0
    buffer_load_dwordx4 v9, s[8:11], s38 offen sc1 lds
    s_add_u32 m0, s42, 0x18800
    s_nop 0
    buffer_load_dwordx4 v10, s[8:11], s38 offen sc1 lds
    s_add_u32 m0, s42, 0x18c00
    s_nop 0
    buffer_load_dwordx4 v11, s[8:11], s38 offen sc1 lds
    s_add_u32 m0, s43, 0x18000
    s_nop 0
    buffer_load_dwordx4 v12, s[12:15], s39 offen lds
    s_add_u32 m0, s43, 0x18400
    s_nop 0
    buffer_load_dwordx4 v13, s[12:15], s39 offen lds
    s_add_u32 m0, s43, 0x18800
    s_nop 0
    buffer_load_dwordx4 v14, s[12:15], s39 offen lds
    s_add_u32 m0, s43, 0x18c00
    s_nop 0
    buffer_load_dwordx4 v15, s[12:15], s39 offen lds
    s_waitcnt vmcnt(16)
    s_barrier
    s_add_u32 s38, s72, 0x400
    s_add_u32 s39, s74, 0x100000
    s_add_u32 m0, s42, 0x0
    s_nop 0
    buffer_load_dwordx4 v8, s[8:11], s38 offen sc1 lds
    s_add_u32 m0, s42, 0x400
    s_nop 0
    buffer_load_dwordx4 v9, s[8:11], s38 offen sc1 lds
    s_add_u32 m0, s42, 0x800
    s_nop 0
    buffer_load_dwordx4 v10, s[8:11], s38 offen sc1 lds
    s_add_u32 m0, s42, 0xc00
    s_nop 0
    buffer_load_dwordx4 v11, s[8:11], s38 offen sc1 lds
    s_add_u32 m0, s43, 0x0
    s_nop 0
    buffer_load_dwordx4 v12, s[12:15], s39 offen lds
    s_add_u32 m0, s43, 0x400
    s_nop 0
    buffer_load_dwordx4 v13, s[12:15], s39 offen lds
    s_add_u32 m0, s43, 0x800
    s_nop 0
    buffer_load_dwordx4 v14, s[12:15], s39 offen lds
    s_add_u32 m0, s43, 0xc00
    s_nop 0
    buffer_load_dwordx4 v15, s[12:15], s39 offen lds
    s_waitcnt vmcnt(16)
    s_barrier
    s_add_u32 s38, s72, 0x480
    s_add_u32 s39, s74, 0x120000
    s_add_u32 m0, s42, 0x8000
    s_nop 0
    buffer_load_dwordx4 v8, s[8:11], s38 offen sc1 lds
    s_add_u32 m0, s42, 0x8400
    s_nop 0
    buffer_load_dwordx4 v9, s[8:11], s38 offen sc1 lds
    s_add_u32 m0, s42, 0x8800
    s_nop 0
    buffer_load_dwordx4 v10, s[8:11], s38 offen sc1 lds
    s_add_u32 m0, s42, 0x8c00
    s_nop 0
    buffer_load_dwordx4 v11, s[8:11], s38 offen sc1 lds
    s_add_u32 m0, s43, 0x8000
    s_nop 0
    buffer_load_dwordx4 v12, s[12:15], s39 offen lds
    s_add_u32 m0, s43, 0x8400
    s_nop 0
    buffer_load_dwordx4 v13, s[12:15], s39 offen lds
    s_add_u32 m0, s43, 0x8800
    s_nop 0
    buffer_load_dwordx4 v14, s[12:15], s39 offen lds
    s_add_u32 m0, s43, 0x8c00
    s_nop 0
    buffer_load_dwordx4 v15, s[12:15], s39 offen lds
    s_waitcnt vmcnt(16)
    s_barrier
    s_add_u32 s38, s72, 0x500
    s_add_u32 s39, s74, 0x140000
    s_add_u32 m0, s42, 0x10000
    s_nop 0
    buffer_load_dwordx4 v8, s[8:11], s38 offen sc1 lds
    s_add_u32 m0, s42, 0x10400
    s_nop 0
    buffer_load_dwordx4 v9, s[8:11], s38 offen sc1 lds
    s_add_u32 m0, s42, 0x10800
    s_nop 0
    buffer_load_dwordx4 v10, s[8:11], s38 offen sc1 lds
    s_add_u32 m0, s42, 0x10c00
    s_nop 0
    buffer_load_dwordx4 v11, s[8:11], s38 offen sc1 lds
    s_add_u32 m0, s43, 0x10000
    s_nop 0
    buffer_load_dwordx4 v12, s[12:15], s39 offen lds
    s_add_u32 m0, s43, 0x10400
    s_nop 0
    buffer_load_dwordx4 v13, s[12:15], s39 offen lds
    s_add_u32 m0, s43, 0x10800
    s_nop 0
    buffer_load_dwordx4 v14, s[12:15], s39 offen lds
    s_add_u32 m0, s43, 0x10c00
    s_nop 0
    buffer_load_dwordx4 v15, s[12:15], s39 offen lds
    s_waitcnt vmcnt(16)
    s_barrier
    s_add_u32 s38, s72, 0x580
    s_add_u32 s39, s74, 0x160000
    s_add_u32 m0, s42, 0x18000
    s_nop 0
    buffer_load_dwordx4 v8, s[8:11], s38 offen sc1 lds
    s_add_u32 m0, s42, 0x18400
    s_nop 0
    buffer_load_dwordx4 v9, s[8:11], s38 offen sc1 lds
    s_add_u32 m0, s42, 0x18800
    s_nop 0
    buffer_load_dwordx4 v10, s[8:11], s38 offen sc1 lds
    s_add_u32 m0, s42, 0x18c00
    s_nop 0
    buffer_load_dwordx4 v11, s[8:11], s38 offen sc1 lds
    s_add_u32 m0, s43, 0x18000
    s_nop 0
    buffer_load_dwordx4 v12, s[12:15], s39 offen lds
    s_add_u32 m0, s43, 0x18400
    s_nop 0
    buffer_load_dwordx4 v13, s[12:15], s39 offen lds
    s_add_u32 m0, s43, 0x18800
    s_nop 0
    buffer_load_dwordx4 v14, s[12:15], s39 offen lds
    s_add_u32 m0, s43, 0x18c00
    s_nop 0
    buffer_load_dwordx4 v15, s[12:15], s39 offen lds
    s_waitcnt vmcnt(16)
    s_barrier
    s_add_u32 s38, s72, 0x600
    s_add_u32 s39, s74, 0x180000
    s_add_u32 m0, s42, 0x0
    s_nop 0
    buffer_load_dwordx4 v8, s[8:11], s38 offen sc1 lds
    s_add_u32 m0, s42, 0x400
    s_nop 0
    buffer_load_dwordx4 v9, s[8:11], s38 offen sc1 lds
    s_add_u32 m0, s42, 0x800
    s_nop 0
    buffer_load_dwordx4 v10, s[8:11], s38 offen sc1 lds
    s_add_u32 m0, s42, 0xc00
    s_nop 0
    buffer_load_dwordx4 v11, s[8:11], s38 offen sc1 lds
    s_add_u32 m0, s43, 0x0
    s_nop 0
    buffer_load_dwordx4 v12, s[12:15], s39 offen lds
    s_add_u32 m0, s43, 0x400
    s_nop 0
    buffer_load_dwordx4 v13, s[12:15], s39 offen lds
    s_add_u32 m0, s43, 0x800
    s_nop 0
    buffer_load_dwordx4 v14, s[12:15], s39 offen lds
    s_add_u32 m0, s43, 0xc00
    s_nop 0
    buffer_load_dwordx4 v15, s[12:15], s39 offen lds
    s_waitcnt vmcnt(16)
    s_barrier
    s_add_u32 s38, s72, 0x680
    s_add_u32 s39, s74, 0x1a0000
    s_add_u32 m0, s42, 0x8000
    s_nop 0
    buffer_load_dwordx4 v8, s[8:11], s38 offen sc1 lds
    s_add_u32 m0, s42, 0x8400
    s_nop 0
    buffer_load_dwordx4 v9, s[8:11], s38 offen sc1 lds
    s_add_u32 m0, s42, 0x8800
    s_nop 0
    buffer_load_dwordx4 v10, s[8:11], s38 offen sc1 lds
    s_add_u32 m0, s42, 0x8c00
    s_nop 0
    buffer_load_dwordx4 v11, s[8:11], s38 offen sc1 lds
    s_add_u32 m0, s43, 0x8000
    s_nop 0
    buffer_load_dwordx4 v12, s[12:15], s39 offen lds
    s_add_u32 m0, s43, 0x8400
    s_nop 0
    buffer_load_dwordx4 v13, s[12:15], s39 offen lds
    s_add_u32 m0, s43, 0x8800
    s_nop 0
    buffer_load_dwordx4 v14, s[12:15], s39 offen lds
    s_add_u32 m0, s43, 0x8c00
    s_nop 0
    buffer_load_dwordx4 v15, s[12:15], s39 offen lds
    s_waitcnt vmcnt(16)
    s_barrier
    s_add_u32 s38, s72, 0x700
    s_add_u32 s39, s74, 0x1c0000
    s_add_u32 m0, s42, 0x10000
    s_nop 0
    buffer_load_dwordx4 v8, s[8:11], s38 offen sc1 lds
    s_add_u32 m0, s42, 0x10400
    s_nop 0
    buffer_load_dwordx4 v9, s[8:11], s38 offen sc1 lds
    s_add_u32 m0, s42, 0x10800
    s_nop 0
    buffer_load_dwordx4 v10, s[8:11], s38 offen sc1 lds
    s_add_u32 m0, s42, 0x10c00
    s_nop 0
    buffer_load_dwordx4 v11, s[8:11], s38 offen sc1 lds
    s_add_u32 m0, s43, 0x10000
    s_nop 0
    buffer_load_dwordx4 v12, s[12:15], s39 offen lds
    s_add_u32 m0, s43, 0x10400
    s_nop 0
    buffer_load_dwordx4 v13, s[12:15], s39 offen lds
    s_add_u32 m0, s43, 0x10800
    s_nop 0
    buffer_load_dwordx4 v14, s[12:15], s39 offen lds
    s_add_u32 m0, s43, 0x10c00
    s_nop 0
    buffer_load_dwordx4 v15, s[12:15], s39 offen lds
    s_waitcnt vmcnt(16)
    s_barrier
    s_add_u32 s38, s72, 0x780
    s_add_u32 s39, s74, 0x1e0000
    s_add_u32 m0, s42, 0x18000
    s_nop 0
    buffer_load_dwordx4 v8, s[8:11], s38 offen sc1 lds
    s_add_u32 m0, s42, 0x18400
    s_nop 0
    buffer_load_dwordx4 v9, s[8:11], s38 offen sc1 lds
    s_add_u32 m0, s42, 0x18800
    s_nop 0
    buffer_load_dwordx4 v10, s[8:11], s38 offen sc1 lds
    s_add_u32 m0, s42, 0x18c00
    s_nop 0
    buffer_load_dwordx4 v11, s[8:11], s38 offen sc1 lds
    s_add_u32 m0, s43, 0x18000
    s_nop 0
    buffer_load_dwordx4 v12, s[12:15], s39 offen lds
    s_add_u32 m0, s43, 0x18400
    s_nop 0
    buffer_load_dwordx4 v13, s[12:15], s39 offen lds
    s_add_u32 m0, s43, 0x18800
    s_nop 0
    buffer_load_dwordx4 v14, s[12:15], s39 offen lds
    s_add_u32 m0, s43, 0x18c00
    s_nop 0
    buffer_load_dwordx4 v15, s[12:15], s39 offen lds
    s_waitcnt vmcnt(16)
    s_barrier
    s_add_u32 s38, s72, 0x800
    s_add_u32 s39, s74, 0x200000
    s_add_u32 m0, s42, 0x0
    s_nop 0
    buffer_load_dwordx4 v8, s[8:11], s38 offen sc1 lds
    s_add_u32 m0, s42, 0x400
    s_nop 0
    buffer_load_dwordx4 v9, s[8:11], s38 offen sc1 lds
    s_add_u32 m0, s42, 0x800
    s_nop 0
    buffer_load_dwordx4 v10, s[8:11], s38 offen sc1 lds
    s_add_u32 m0, s42, 0xc00
    s_nop 0
    buffer_load_dwordx4 v11, s[8:11], s38 offen sc1 lds
    s_add_u32 m0, s43, 0x0
    s_nop 0
    buffer_load_dwordx4 v12, s[12:15], s39 offen lds
    s_add_u32 m0, s43, 0x400
    s_nop 0
    buffer_load_dwordx4 v13, s[12:15], s39 offen lds
    s_add_u32 m0, s43, 0x800
    s_nop 0
    buffer_load_dwordx4 v14, s[12:15], s39 offen lds
    s_add_u32 m0, s43, 0xc00
    s_nop 0
    buffer_load_dwordx4 v15, s[12:15], s39 offen lds
    s_waitcnt vmcnt(16)
    s_barrier
    s_add_u32 s38, s72, 0x880
    s_add_u32 s39, s74, 0x220000
    s_add_u32 m0, s42, 0x8000
    s_nop 0
    buffer_load_dwordx4 v8, s[8:11], s38 offen sc1 lds
    s_add_u32 m0, s42, 0x8400
    s_nop 0
    buffer_load_dwordx4 v9, s[8:11], s38 offen sc1 lds
    s_add_u32 m0, s42, 0x8800
    s_nop 0
    buffer_load_dwordx4 v10, s[8:11], s38 offen sc1 lds
    s_add_u32 m0, s42, 0x8c00
    s_nop 0
    buffer_load_dwordx4 v11, s[8:11], s38 offen sc1 lds
    s_add_u32 m0, s43, 0x8000
    s_nop 0
    buffer_load_dwordx4 v12, s[12:15], s39 offen lds
    s_add_u32 m0, s43, 0x8400
    s_nop 0
    buffer_load_dwordx4 v13, s[12:15], s39 offen lds
    s_add_u32 m0, s43, 0x8800
    s_nop 0
    buffer_load_dwordx4 v14, s[12:15], s39 offen lds
    s_add_u32 m0, s43, 0x8c00
    s_nop 0
    buffer_load_dwordx4 v15, s[12:15], s39 offen lds
    s_waitcnt vmcnt(16)
    s_barrier
    s_add_u32 s38, s72, 0x900
    s_add_u32 s39, s74, 0x240000
    s_add_u32 m0, s42, 0x10000
    s_nop 0
    buffer_load_dwordx4 v8, s[8:11], s38 offen sc1 lds
    s_add_u32 m0, s42, 0x10400
    s_nop 0
    buffer_load_dwordx4 v9, s[8:11], s38 offen sc1 lds
    s_add_u32 m0, s42, 0x10800
    s_nop 0
    buffer_load_dwordx4 v10, s[8:11], s38 offen sc1 lds
    s_add_u32 m0, s42, 0x10c00
    s_nop 0
    buffer_load_dwordx4 v11, s[8:11], s38 offen sc1 lds
    s_add_u32 m0, s43, 0x10000
    s_nop 0
    buffer_load_dwordx4 v12, s[12:15], s39 offen lds
    s_add_u32 m0, s43, 0x10400
    s_nop 0
    buffer_load_dwordx4 v13, s[12:15], s39 offen lds
    s_add_u32 m0, s43, 0x10800
    s_nop 0
    buffer_load_dwordx4 v14, s[12:15], s39 offen lds
    s_add_u32 m0, s43, 0x10c00
    s_nop 0
    buffer_load_dwordx4 v15, s[12:15], s39 offen lds
    s_waitcnt vmcnt(16)
    s_barrier
    s_add_u32 s38, s72, 0x980
    s_add_u32 s39, s74, 0x260000
    s_add_u32 m0, s42, 0x18000
    s_nop 0
    buffer_load_dwordx4 v8, s[8:11], s38 offen sc1 lds
    s_add_u32 m0, s42, 0x18400
    s_nop 0
    buffer_load_dwordx4 v9, s[8:11], s38 offen sc1 lds
    s_add_u32 m0, s42, 0x18800
    s_nop 0
    buffer_load_dwordx4 v10, s[8:11], s38 offen sc1 lds
    s_add_u32 m0, s42, 0x18c00
    s_nop 0
    buffer_load_dwordx4 v11, s[8:11], s38 offen sc1 lds
    s_add_u32 m0, s43, 0x18000
    s_nop 0
    buffer_load_dwordx4 v12, s[12:15], s39 offen lds
    s_add_u32 m0, s43, 0x18400
    s_nop 0
    buffer_load_dwordx4 v13, s[12:15], s39 offen lds
    s_add_u32 m0, s43, 0x18800
    s_nop 0
    buffer_load_dwordx4 v14, s[12:15], s39 offen lds
    s_add_u32 m0, s43, 0x18c00
    s_nop 0
    buffer_load_dwordx4 v15, s[12:15], s39 offen lds
    s_waitcnt vmcnt(16)
    s_barrier
    s_add_u32 s38, s72, 0xa00
    s_add_u32 s39, s74, 0x280000
    s_add_u32 m0, s42, 0x0
    s_nop 0
    buffer_load_dwordx4 v8, s[8:11], s38 offen sc1 lds
    s_add_u32 m0, s42, 0x400
    s_nop 0
    buffer_load_dwordx4 v9, s[8:11], s38 offen sc1 lds
    s_add_u32 m0, s42, 0x800
    s_nop 0
    buffer_load_dwordx4 v10, s[8:11], s38 offen sc1 lds
    s_add_u32 m0, s42, 0xc00
    s_nop 0
    buffer_load_dwordx4 v11, s[8:11], s38 offen sc1 lds
    s_add_u32 m0, s43, 0x0
    s_nop 0
    buffer_load_dwordx4 v12, s[12:15], s39 offen lds
    s_add_u32 m0, s43, 0x400
    s_nop 0
    buffer_load_dwordx4 v13, s[12:15], s39 offen lds
    s_add_u32 m0, s43, 0x800
    s_nop 0
    buffer_load_dwordx4 v14, s[12:15], s39 offen lds
    s_add_u32 m0, s43, 0xc00
    s_nop 0
    buffer_load_dwordx4 v15, s[12:15], s39 offen lds
    s_waitcnt vmcnt(16)
    s_barrier
    s_add_u32 s38, s72, 0xa80
    s_add_u32 s39, s74, 0x2a0000
    s_add_u32 m0, s42, 0x8000
    s_nop 0
    buffer_load_dwordx4 v8, s[8:11], s38 offen sc1 lds
    s_add_u32 m0, s42, 0x8400
    s_nop 0
    buffer_load_dwordx4 v9, s[8:11], s38 offen sc1 lds
    s_add_u32 m0, s42, 0x8800
    s_nop 0
    buffer_load_dwordx4 v10, s[8:11], s38 offen sc1 lds
    s_add_u32 m0, s42, 0x8c00
    s_nop 0
    buffer_load_dwordx4 v11, s[8:11], s38 offen sc1 lds
    s_add_u32 m0, s43, 0x8000
    s_nop 0
    buffer_load_dwordx4 v12, s[12:15], s39 offen lds
    s_add_u32 m0, s43, 0x8400
    s_nop 0
    buffer_load_dwordx4 v13, s[12:15], s39 offen lds
    s_add_u32 m0, s43, 0x8800
    s_nop 0
    buffer_load_dwordx4 v14, s[12:15], s39 offen lds
    s_add_u32 m0, s43, 0x8c00
    s_nop 0
    buffer_load_dwordx4 v15, s[12:15], s39 offen lds
    s_waitcnt vmcnt(16)
    s_barrier
    s_add_u32 s38, s72, 0xb00
    s_add_u32 s39, s74, 0x2c0000
    s_add_u32 m0, s5, 0x10000
    s_nop 0
    buffer_load_dwordx4 v16, s[8:11], s38 offen sc1 lds
    s_add_u32 m0, s5, 0x10400
    s_nop 0
    buffer_load_dwordx4 v17, s[8:11], s38 offen sc1 lds
    s_add_u32 m0, s43, 0x10000
    s_nop 0
    buffer_load_dwordx4 v12, s[12:15], s39 offen lds
    s_add_u32 m0, s43, 0x10400
    s_nop 0
    buffer_load_dwordx4 v13, s[12:15], s39 offen lds
    s_add_u32 m0, s43, 0x10800
    s_nop 0
    buffer_load_dwordx4 v14, s[12:15], s39 offen lds
    s_add_u32 m0, s43, 0x10c00
    s_nop 0
    buffer_load_dwordx4 v15, s[12:15], s39 offen lds
    s_waitcnt vmcnt(14)
    s_barrier
    s_add_u32 s38, s72, 0xb80
    s_add_u32 s39, s74, 0x2e0000
    s_add_u32 m0, s5, 0x18000
    s_nop 0
    buffer_load_dwordx4 v16, s[8:11], s38 offen sc1 lds
    s_add_u32 m0, s5, 0x18400
    s_nop 0
    buffer_load_dwordx4 v17, s[8:11], s38 offen sc1 lds
    s_add_u32 m0, s43, 0x18000
    s_nop 0
    buffer_load_dwordx4 v12, s[12:15], s39 offen lds
    s_add_u32 m0, s43, 0x18400
    s_nop 0
    buffer_load_dwordx4 v13, s[12:15], s39 offen lds
    s_add_u32 m0, s43, 0x18800
    s_nop 0
    buffer_load_dwordx4 v14, s[12:15], s39 offen lds
    s_add_u32 m0, s43, 0x18c00
    s_nop 0
    buffer_load_dwordx4 v15, s[12:15], s39 offen lds
    s_waitcnt vmcnt(12)
    s_barrier
    s_add_u32 s38, s72, 0xc00
    s_add_u32 s39, s74, 0x300000
    s_add_u32 m0, s5, 0x0
    s_nop 0
    buffer_load_dwordx4 v16, s[8:11], s38 offen sc1 lds
    s_add_u32 m0, s5, 0x400
    s_nop 0
    buffer_load_dwordx4 v17, s[8:11], s38 offen sc1 lds
    s_add_u32 m0, s43, 0x0
    s_nop 0
    buffer_load_dwordx4 v12, s[12:15], s39 offen lds
    s_add_u32 m0, s43, 0x400
    s_nop 0
    buffer_load_dwordx4 v13, s[12:15], s39 offen lds
    s_add_u32 m0, s43, 0x800
    s_nop 0
    buffer_load_dwordx4 v14, s[12:15], s39 offen lds
    s_add_u32 m0, s43, 0xc00
    s_nop 0
    buffer_load_dwordx4 v15, s[12:15], s39 offen lds
    s_waitcnt vmcnt(12)
    s_barrier
    s_add_u32 s38, s72, 0xc80
    s_add_u32 s39, s74, 0x320000
    s_add_u32 m0, s5, 0x8000
    s_nop 0
    buffer_load_dwordx4 v16, s[8:11], s38 offen sc1 lds
    s_add_u32 m0, s5, 0x8400
    s_nop 0
    buffer_load_dwordx4 v17, s[8:11], s38 offen sc1 lds
    s_add_u32 m0, s43, 0x8000
    s_nop 0
    buffer_load_dwordx4 v12, s[12:15], s39 offen lds
    s_add_u32 m0, s43, 0x8400
    s_nop 0
    buffer_load_dwordx4 v13, s[12:15], s39 offen lds
    s_add_u32 m0, s43, 0x8800
    s_nop 0
    buffer_load_dwordx4 v14, s[12:15], s39 offen lds
    s_add_u32 m0, s43, 0x8c00
    s_nop 0
    buffer_load_dwordx4 v15, s[12:15], s39 offen lds
    s_waitcnt vmcnt(12)
    s_barrier
    s_add_u32 s38, s72, 0xd00
    s_add_u32 s39, s74, 0x340000
    s_add_u32 m0, s5, 0x10000
    s_nop 0
    buffer_load_dwordx4 v16, s[8:11], s38 offen sc1 lds
    s_add_u32 m0, s5, 0x10400
    s_nop 0
    buffer_load_dwordx4 v17, s[8:11], s38 offen sc1 lds
    s_add_u32 m0, s43, 0x10000
    s_nop 0
    buffer_load_dwordx4 v12, s[12:15], s39 offen lds
    s_add_u32 m0, s43, 0x10400
    s_nop 0
    buffer_load_dwordx4 v13, s[12:15], s39 offen lds
    s_add_u32 m0, s43, 0x10800
    s_nop 0
    buffer_load_dwordx4 v14, s[12:15], s39 offen lds
    s_add_u32 m0, s43, 0x10c00
    s_nop 0
    buffer_load_dwordx4 v15, s[12:15], s39 offen lds
    s_waitcnt vmcnt(12)
    s_barrier
    s_add_u32 s38, s72, 0xd80
    s_add_u32 s39, s74, 0x360000
    s_add_u32 m0, s5, 0x18000
    s_nop 0
    buffer_load_dwordx4 v16, s[8:11], s38 offen sc1 lds
    s_add_u32 m0, s5, 0x18400
    s_nop 0
    buffer_load_dwordx4 v17, s[8:11], s38 offen sc1 lds
    s_add_u32 m0, s43, 0x18000
    s_nop 0
    buffer_load_dwordx4 v12, s[12:15], s39 offen lds
    s_add_u32 m0, s43, 0x18400
    s_nop 0
    buffer_load_dwordx4 v13, s[12:15], s39 offen lds
    s_add_u32 m0, s43, 0x18800
    s_nop 0
    buffer_load_dwordx4 v14, s[12:15], s39 offen lds
    s_add_u32 m0, s43, 0x18c00
    s_nop 0
    buffer_load_dwordx4 v15, s[12:15], s39 offen lds
    s_waitcnt vmcnt(12)
    s_barrier
    s_add_u32 s38, s73, 0xb00
    s_add_u32 s39, s75, 0x2c0000
    s_add_u32 m0, s5, 0x0
    s_nop 0
    buffer_load_dwordx4 v16, s[8:11], s38 offen sc1 lds
    s_add_u32 m0, s5, 0x400
    s_nop 0
    buffer_load_dwordx4 v17, s[8:11], s38 offen sc1 lds
    s_add_u32 m0, s43, 0x0
    s_nop 0
    buffer_load_dwordx4 v12, s[12:15], s39 offen lds
    s_add_u32 m0, s43, 0x400
    s_nop 0
    buffer_load_dwordx4 v13, s[12:15], s39 offen lds
    s_add_u32 m0, s43, 0x800
    s_nop 0
    buffer_load_dwordx4 v14, s[12:15], s39 offen lds
    s_add_u32 m0, s43, 0xc00
    s_nop 0
    buffer_load_dwordx4 v15, s[12:15], s39 offen lds
    s_waitcnt vmcnt(12)
    s_barrier
    s_add_u32 s38, s73, 0xb80
    s_add_u32 s39, s75, 0x2e0000
    s_add_u32 m0, s5, 0x8000
    s_nop 0
    buffer_load_dwordx4 v16, s[8:11], s38 offen sc1 lds
    s_add_u32 m0, s5, 0x8400
    s_nop 0
    buffer_load_dwordx4 v17, s[8:11], s38 offen sc1 lds
    s_add_u32 m0, s43, 0x8000
    s_nop 0
    buffer_load_dwordx4 v12, s[12:15], s39 offen lds
    s_add_u32 m0, s43, 0x8400
    s_nop 0
    buffer_load_dwordx4 v13, s[12:15], s39 offen lds
    s_add_u32 m0, s43, 0x8800
    s_nop 0
    buffer_load_dwordx4 v14, s[12:15], s39 offen lds
    s_add_u32 m0, s43, 0x8c00
    s_nop 0
    buffer_load_dwordx4 v15, s[12:15], s39 offen lds
    s_waitcnt vmcnt(12)
    s_barrier
    s_add_u32 s38, s73, 0xc00
    s_add_u32 s39, s75, 0x300000
    s_add_u32 m0, s5, 0x10000
    s_nop 0
    buffer_load_dwordx4 v16, s[8:11], s38 offen sc1 lds
    s_add_u32 m0, s5, 0x10400
    s_nop 0
    buffer_load_dwordx4 v17, s[8:11], s38 offen sc1 lds
    s_add_u32 m0, s43, 0x10000
    s_nop 0
    buffer_load_dwordx4 v12, s[12:15], s39 offen lds
    s_add_u32 m0, s43, 0x10400
    s_nop 0
    buffer_load_dwordx4 v13, s[12:15], s39 offen lds
    s_add_u32 m0, s43, 0x10800
    s_nop 0
    buffer_load_dwordx4 v14, s[12:15], s39 offen lds
    s_add_u32 m0, s43, 0x10c00
    s_nop 0
    buffer_load_dwordx4 v15, s[12:15], s39 offen lds
    s_waitcnt vmcnt(12)
    s_barrier
    s_add_u32 s38, s73, 0xc80
    s_add_u32 s39, s75, 0x320000
    s_add_u32 m0, s5, 0x18000
    s_nop 0
    buffer_load_dwordx4 v16, s[8:11], s38 offen sc1 lds
    s_add_u32 m0, s5, 0x18400
    s_nop 0
    buffer_load_dwordx4 v17, s[8:11], s38 offen sc1 lds
    s_add_u32 m0, s43, 0x18000
    s_nop 0
    buffer_load_dwordx4 v12, s[12:15], s39 offen lds
    s_add_u32 m0, s43, 0x18400
    s_nop 0
    buffer_load_dwordx4 v13, s[12:15], s39 offen lds
    s_add_u32 m0, s43, 0x18800
    s_nop 0
    buffer_load_dwordx4 v14, s[12:15], s39 offen lds
    s_add_u32 m0, s43, 0x18c00
    s_nop 0
    buffer_load_dwordx4 v15, s[12:15], s39 offen lds
    s_waitcnt vmcnt(12)
    s_barrier
    s_add_u32 s38, s73, 0xd00
    s_add_u32 s39, s75, 0x340000
    s_add_u32 m0, s5, 0x0
    s_nop 0
    buffer_load_dwordx4 v16, s[8:11], s38 offen sc1 lds
    s_add_u32 m0, s5, 0x400
    s_nop 0
    buffer_load_dwordx4 v17, s[8:11], s38 offen sc1 lds
    s_add_u32 m0, s43, 0x0
    s_nop 0
    buffer_load_dwordx4 v12, s[12:15], s39 offen lds
    s_add_u32 m0, s43, 0x400
    s_nop 0
    buffer_load_dwordx4 v13, s[12:15], s39 offen lds
    s_add_u32 m0, s43, 0x800
    s_nop 0
    buffer_load_dwordx4 v14, s[12:15], s39 offen lds
    s_add_u32 m0, s43, 0xc00
    s_nop 0
    buffer_load_dwordx4 v15, s[12:15], s39 offen lds
    s_waitcnt vmcnt(12)
    s_barrier
    s_add_u32 s38, s73, 0xd80
    s_add_u32 s39, s75, 0x360000
    s_add_u32 m0, s5, 0x8000
    s_nop 0
    buffer_load_dwordx4 v16, s[8:11], s38 offen sc1 lds
    s_add_u32 m0, s5, 0x8400
    s_nop 0
    buffer_load_dwordx4 v17, s[8:11], s38 offen sc1 lds
    s_add_u32 m0, s43, 0x8000
    s_nop 0
    buffer_load_dwordx4 v12, s[12:15], s39 offen lds
    s_add_u32 m0, s43, 0x8400
    s_nop 0
    buffer_load_dwordx4 v13, s[12:15], s39 offen lds
    s_add_u32 m0, s43, 0x8800
    s_nop 0
    buffer_load_dwordx4 v14, s[12:15], s39 offen lds
    s_add_u32 m0, s43, 0x8c00
    s_nop 0
    buffer_load_dwordx4 v15, s[12:15], s39 offen lds
    s_lshl_b32 s44, s32, 7
    s_add_u32 s44, s44, 0
    v_add_u32 v5, s44, v2
    v_lshrrev_b32 v3, 4, v5
    v_and_b32 v4, 15, v5
    v_add_u32 v3, s33, v3
    s_lshl_b32 s45, s55, 6
    v_add_u32 v3, s45, v3
    v_lshlrev_b32 v4, 4, v4
    s_lshl_b32 s45, s34, 1
    v_add_u32 v4, s45, v4
    v_mul_u32_u24 v5, 2048, v3
    v_add_u32 v248, v5, v4
    v_mul_u32_u24 v5, 2176, v3
    v_add_u32 v252, v5, v4
    buffer_load_dwordx4 v[240:243], v252, s[16:19], 0 offen sc1
    s_lshl_b32 s44, s32, 7
    s_add_u32 s44, s44, 64
    v_add_u32 v5, s44, v2
    v_lshrrev_b32 v3, 4, v5
    v_and_b32 v4, 15, v5
    v_add_u32 v3, s33, v3
    s_lshl_b32 s45, s55, 6
    v_add_u32 v3, s45, v3
    v_lshlrev_b32 v4, 4, v4
    s_lshl_b32 s45, s34, 1
    v_add_u32 v4, s45, v4
    v_mul_u32_u24 v5, 2048, v3
    v_add_u32 v249, v5, v4
    v_mul_u32_u24 v5, 2176, v3
    v_add_u32 v253, v5, v4
    buffer_load_dwordx4 v[244:247], v253, s[16:19], 0 offen sc1
    s_waitcnt vmcnt(14)
    s_barrier
    s_waitcnt vmcnt(8)
    s_barrier
    s_waitcnt vmcnt(2)
    s_barrier
    s_barrier
    s_barrier
k4_kernel_store:
    s_barrier
    v_and_b32 v2, 63, v0
    s_lshl_b32 s44, s32, 7
    s_add_u32 s44, s44, 0
    v_add_u32 v5, s44, v2
    v_lshrrev_b32 v3, 4, v5
    v_and_b32 v4, 15, v5
    v_mul_u32_u24 v6, 272, v3
    v_lshl_add_u32 v6, v4, 4, v6
    ds_read_b128 v[32:35], v6
    s_lshl_b32 s44, s32, 7
    s_add_u32 s44, s44, 64
    v_add_u32 v5, s44, v2
    v_lshrrev_b32 v3, 4, v5
    v_and_b32 v4, 15, v5
    v_mul_u32_u24 v6, 272, v3
    v_lshl_add_u32 v6, v4, 4, v6
    ds_read_b128 v[36:39], v6
    s_waitcnt vmcnt(0) lgkmcnt(0)
    v_lshlrev_b32 v8, 16, v32
    v_lshlrev_b32 v9, 16, v240
    v_and_b32 v10, s52, v32
    v_and_b32 v11, s52, v240
    v_add_f32 v8, v8, v9
    v_add_f32 v10, v10, v11
    v_cvt_pk_bf16_f32 v32, v8, v10
    v_lshlrev_b32 v8, 16, v33
    v_lshlrev_b32 v9, 16, v241
    v_and_b32 v10, s52, v33
    v_and_b32 v11, s52, v241
    v_add_f32 v8, v8, v9
    v_add_f32 v10, v10, v11
    v_cvt_pk_bf16_f32 v33, v8, v10
    v_lshlrev_b32 v8, 16, v34
    v_lshlrev_b32 v9, 16, v242
    v_and_b32 v10, s52, v34
    v_and_b32 v11, s52, v242
    v_add_f32 v8, v8, v9
    v_add_f32 v10, v10, v11
    v_cvt_pk_bf16_f32 v34, v8, v10
    v_lshlrev_b32 v8, 16, v35
    v_lshlrev_b32 v9, 16, v243
    v_and_b32 v10, s52, v35
    v_and_b32 v11, s52, v243
    v_add_f32 v8, v8, v9
    v_add_f32 v10, v10, v11
    v_cvt_pk_bf16_f32 v35, v8, v10
    buffer_store_dwordx4 v[32:35], v248, s[20:23], 0 offen sc1
    v_lshlrev_b32 v8, 16, v36
    v_lshlrev_b32 v9, 16, v244
    v_and_b32 v10, s52, v36
    v_and_b32 v11, s52, v244
    v_add_f32 v8, v8, v9
    v_add_f32 v10, v10, v11
    v_cvt_pk_bf16_f32 v36, v8, v10
    v_lshlrev_b32 v8, 16, v37
    v_lshlrev_b32 v9, 16, v245
    v_and_b32 v10, s52, v37
    v_and_b32 v11, s52, v245
    v_add_f32 v8, v8, v9
    v_add_f32 v10, v10, v11
    v_cvt_pk_bf16_f32 v37, v8, v10
    v_lshlrev_b32 v8, 16, v38
    v_lshlrev_b32 v9, 16, v246
    v_and_b32 v10, s52, v38
    v_and_b32 v11, s52, v246
    v_add_f32 v8, v8, v9
    v_add_f32 v10, v10, v11
    v_cvt_pk_bf16_f32 v38, v8, v10
    v_lshlrev_b32 v8, 16, v39
    v_lshlrev_b32 v9, 16, v247
    v_and_b32 v10, s52, v39
    v_and_b32 v11, s52, v247
    v_add_f32 v8, v8, v9
    v_add_f32 v10, v10, v11
    v_cvt_pk_bf16_f32 v39, v8, v10
    buffer_store_dwordx4 v[36:39], v249, s[20:23], 0 offen sc1
k4_kernel_fin:
k4_kernel_finnw:
k4_kernel_done:
    s_endpgm
k4_kernel_cons:
    s_lshr_b32 s36, s32, 1
    s_and_b32 s37, s32, 1
    v_and_b32 v3, 15, v2
    v_lshrrev_b32 v4, 4, v2
    s_lshl_b32 s44, s36, 13
    v_lshlrev_b32 v5, 7, v3
    v_lshrrev_b32 v6, 1, v3
    v_xor_b32 v6, v6, v4
    v_lshlrev_b32 v6, 4, v6
    v_add3_u32 v8, v5, v6, s44
    v_xor_b32 v9, 64, v8
    v_lshrrev_b32 v5, 2, v3
    v_lshl_add_u32 v6, v4, 3, v5
    v_and_b32 v7, 3, v2
    v_lshlrev_b32 v6, 8, v6
    v_lshl_add_u32 v6, v7, 3, v6
    v_and_b32 v7, 1, v4
    v_lshl_or_b32 v5, v7, 2, v5
    s_lshl_b32 s44, s37, 2
    v_xor_b32 v5, s44, v5
    v_lshl_add_u32 v6, v5, 5, v6
    v_add_u32 v12, 16384, v6
    v_xor_b32 v13, 32, v12
    v_xor_b32 v14, 64, v12
    v_xor_b32 v15, 96, v12
    v_mov_b32 v128, 0
    v_mov_b32 v129, 0
    v_mov_b32 v130, 0
    v_mov_b32 v131, 0
    v_mov_b32 v132, 0
    v_mov_b32 v133, 0
    v_mov_b32 v134, 0
    v_mov_b32 v135, 0
    v_mov_b32 v136, 0
    v_mov_b32 v137, 0
    v_mov_b32 v138, 0
    v_mov_b32 v139, 0
    v_mov_b32 v140, 0
    v_mov_b32 v141, 0
    v_mov_b32 v142, 0
    v_mov_b32 v143, 0
    v_mov_b32 v144, 0
    v_mov_b32 v145, 0
    v_mov_b32 v146, 0
    v_mov_b32 v147, 0
    v_mov_b32 v148, 0
    v_mov_b32 v149, 0
    v_mov_b32 v150, 0
    v_mov_b32 v151, 0
    v_mov_b32 v152, 0
    v_mov_b32 v153, 0
    v_mov_b32 v154, 0
    v_mov_b32 v155, 0
    v_mov_b32 v156, 0
    v_mov_b32 v157, 0
    v_mov_b32 v158, 0
    v_mov_b32 v159, 0
    v_mov_b32 v160, 0
    v_mov_b32 v161, 0
    v_mov_b32 v162, 0
    v_mov_b32 v163, 0
    v_mov_b32 v164, 0
    v_mov_b32 v165, 0
    v_mov_b32 v166, 0
    v_mov_b32 v167, 0
    v_mov_b32 v168, 0
    v_mov_b32 v169, 0
    v_mov_b32 v170, 0
    v_mov_b32 v171, 0
    v_mov_b32 v172, 0
    v_mov_b32 v173, 0
    v_mov_b32 v174, 0
    v_mov_b32 v175, 0
    v_mov_b32 v176, 0
    v_mov_b32 v177, 0
    v_mov_b32 v178, 0
    v_mov_b32 v179, 0
    v_mov_b32 v180, 0
    v_mov_b32 v181, 0
    v_mov_b32 v182, 0
    v_mov_b32 v183, 0
    v_mov_b32 v184, 0
    v_mov_b32 v185, 0
    v_mov_b32 v186, 0
    v_mov_b32 v187, 0
    v_mov_b32 v188, 0
    v_mov_b32 v189, 0
    v_mov_b32 v190, 0
    v_mov_b32 v191, 0
    s_mov_b32 s20, s66
    s_mov_b32 s21, s67
    s_mov_b32 s22, 0x400000
    s_mov_b32 s23, 0x20000
    s_add_u32 s16, s70, 0x500000
    s_addc_u32 s17, s71, 0
    s_mov_b32 s18, 0x440000
    s_mov_b32 s19, 0x20000
    s_mov_b32 s24, s70
    s_mov_b32 s25, s71
    s_mov_b32 s26, 0x2800000
    s_mov_b32 s27, 0x20000
    s_mov_b32 s28, s68
    s_mov_b32 s29, s69
    s_mov_b32 s30, 0x100
    s_mov_b32 s31, 0x20000
    s_mov_b32 s72, s68
    s_mov_b32 s73, s69
    s_mov_b32 s74, 0x100
    s_mov_b32 s75, 0x20000
    v_mov_b32 v24, 0
    buffer_load_dwordx2 v[22:23], v24, s[72:75], 0 offen sc1
    s_mov_b32 s41, 0
    s_cmp_eq_u32 s36, s55
    s_cselect_b32 s40, 34, 22
    s_barrier
    s_lshl_b32 s44, s32, 7
    s_add_u32 s44, s44, 0
    v_add_u32 v5, s44, v2
    v_lshrrev_b32 v3, 4, v5
    v_and_b32 v4, 15, v5
    v_add_u32 v3, s33, v3
    s_lshl_b32 s45, s55, 6
    v_add_u32 v3, s45, v3
    v_lshlrev_b32 v4, 4, v4
    s_lshl_b32 s45, s34, 1
    v_add_u32 v4, s45, v4
    v_mul_u32_u24 v5, 2048, v3
    v_add_u32 v248, v5, v4
    v_mul_u32_u24 v5, 2176, v3
    v_add_u32 v252, v5, v4
    buffer_load_dwordx4 v[240:243], v252, s[16:19], 0 offen sc1
    s_lshl_b32 s44, s32, 7
    s_add_u32 s44, s44, 64
    v_add_u32 v5, s44, v2
    v_lshrrev_b32 v3, 4, v5
    v_and_b32 v4, 15, v5
    v_add_u32 v3, s33, v3
    s_lshl_b32 s45, s55, 6
    v_add_u32 v3, s45, v3
    v_lshlrev_b32 v4, 4, v4
    s_lshl_b32 s45, s34, 1
    v_add_u32 v4, s45, v4
    v_mul_u32_u24 v5, 2048, v3
    v_add_u32 v249, v5, v4
    v_mul_u32_u24 v5, 2176, v3
    v_add_u32 v253, v5, v4
    buffer_load_dwordx4 v[244:247], v253, s[16:19], 0 offen sc1
    s_barrier
    v_add_u32 v10, s41, v8
    v_add_u32 v11, s41, v9
    v_add_u32 v16, s41, v12
    v_add_u32 v17, s41, v13
    v_add_u32 v18, s41, v14
    v_add_u32 v19, s41, v15
    ds_read_b128 v[32:35], v10 offset:0
    ds_read_b64_tr_b16 v[48:49], v16 offset:0
    ds_read_b64_tr_b16 v[50:51], v16 offset:1024
    ds_read_b128 v[36:39], v10 offset:2048
    ds_read_b128 v[40:43], v10 offset:4096
    ds_read_b128 v[44:47], v10 offset:6144
    ds_read_b64_tr_b16 v[52:53], v17 offset:0
    ds_read_b64_tr_b16 v[54:55], v17 offset:1024
    ds_read_b64_tr_b16 v[56:57], v18 offset:0
    ds_read_b64_tr_b16 v[58:59], v18 offset:1024
    ds_read_b64_tr_b16 v[60:61], v19 offset:0
    ds_read_b64_tr_b16 v[62:63], v19 offset:1024
k4_kernel_loop:
    s_cmp_eq_u32 s40, 14
    s_cbranch_scc1 k4_kernel_pfat0
k4_kernel_pfat0_r:
    s_waitcnt lgkmcnt(0)
    v_mfma_f32_16x16x32_bf16 v[128:131], v[48:51], v[32:35], v[128:131]
    ds_read_b128 v[64:67], v11 offset:0
    v_mfma_f32_16x16x32_bf16 v[144:147], v[48:51], v[36:39], v[144:147]
    ds_read_b64_tr_b16 v[80:81], v16 offset:8192
    v_mfma_f32_16x16x32_bf16 v[160:163], v[48:51], v[40:43], v[160:163]
    ds_read_b64_tr_b16 v[82:83], v16 offset:9216
    v_mfma_f32_16x16x32_bf16 v[176:179], v[48:51], v[44:47], v[176:179]
    ds_read_b128 v[68:71], v11 offset:2048
    v_mfma_f32_16x16x32_bf16 v[132:135], v[52:55], v[32:35], v[132:135]
    ds_read_b128 v[72:75], v11 offset:4096
    v_mfma_f32_16x16x32_bf16 v[148:151], v[52:55], v[36:39], v[148:151]
    ds_read_b128 v[76:79], v11 offset:6144
    v_mfma_f32_16x16x32_bf16 v[164:167], v[52:55], v[40:43], v[164:167]
    ds_read_b64_tr_b16 v[84:85], v17 offset:8192
    v_mfma_f32_16x16x32_bf16 v[180:183], v[52:55], v[44:47], v[180:183]
    ds_read_b64_tr_b16 v[86:87], v17 offset:9216
    v_mfma_f32_16x16x32_bf16 v[136:139], v[56:59], v[32:35], v[136:139]
    ds_read_b64_tr_b16 v[88:89], v18 offset:8192
    v_mfma_f32_16x16x32_bf16 v[152:155], v[56:59], v[36:39], v[152:155]
    ds_read_b64_tr_b16 v[90:91], v18 offset:9216
    v_mfma_f32_16x16x32_bf16 v[168:171], v[56:59], v[40:43], v[168:171]
    ds_read_b64_tr_b16 v[92:93], v19 offset:8192
    v_mfma_f32_16x16x32_bf16 v[184:187], v[56:59], v[44:47], v[184:187]
    ds_read_b64_tr_b16 v[94:95], v19 offset:9216
    v_mfma_f32_16x16x32_bf16 v[140:143], v[60:63], v[32:35], v[140:143]
    v_mfma_f32_16x16x32_bf16 v[156:159], v[60:63], v[36:39], v[156:159]
    v_mfma_f32_16x16x32_bf16 v[172:175], v[60:63], v[40:43], v[172:175]
    v_mfma_f32_16x16x32_bf16 v[188:191], v[60:63], v[44:47], v[188:191]
    s_add_u32 s41, s41, 32768
    s_cmp_eq_u32 s41, 131072
    s_cselect_b32 s41, 0, s41
    v_add_u32 v10, s41, v8
    v_add_u32 v16, s41, v12
    v_add_u32 v17, s41, v13
    v_add_u32 v18, s41, v14
    v_add_u32 v19, s41, v15
    s_waitcnt lgkmcnt(0)
    s_barrier
    v_mfma_f32_16x16x32_bf16 v[128:131], v[80:83], v[64:67], v[128:131]
    ds_read_b128 v[32:35], v10 offset:0
    v_mfma_f32_16x16x32_bf16 v[144:147], v[80:83], v[68:71], v[144:147]
    ds_read_b64_tr_b16 v[48:49], v16 offset:0
    v_mfma_f32_16x16x32_bf16 v[160:163], v[80:83], v[72:75], v[160:163]
    ds_read_b64_tr_b16 v[50:51], v16 offset:1024
    v_mfma_f32_16x16x32_bf16 v[176:179], v[80:83], v[76:79], v[176:179]
    ds_read_b128 v[36:39], v10 offset:2048
    v_mfma_f32_16x16x32_bf16 v[132:135], v[84:87], v[64:67], v[132:135]
    ds_read_b128 v[40:43], v10 offset:4096
    v_mfma_f32_16x16x32_bf16 v[148:151], v[84:87], v[68:71], v[148:151]
    ds_read_b128 v[44:47], v10 offset:6144
    v_mfma_f32_16x16x32_bf16 v[164:167], v[84:87], v[72:75], v[164:167]
    ds_read_b64_tr_b16 v[52:53], v17 offset:0
    v_mfma_f32_16x16x32_bf16 v[180:183], v[84:87], v[76:79], v[180:183]
    ds_read_b64_tr_b16 v[54:55], v17 offset:1024
    v_mfma_f32_16x16x32_bf16 v[136:139], v[88:91], v[64:67], v[136:139]
    ds_read_b64_tr_b16 v[56:57], v18 offset:0
    v_mfma_f32_16x16x32_bf16 v[152:155], v[88:91], v[68:71], v[152:155]
    ds_read_b64_tr_b16 v[58:59], v18 offset:1024
    v_mfma_f32_16x16x32_bf16 v[168:171], v[88:91], v[72:75], v[168:171]
    ds_read_b64_tr_b16 v[60:61], v19 offset:0
    v_mfma_f32_16x16x32_bf16 v[184:187], v[88:91], v[76:79], v[184:187]
    ds_read_b64_tr_b16 v[62:63], v19 offset:1024
    v_mfma_f32_16x16x32_bf16 v[140:143], v[92:95], v[64:67], v[140:143]
    v_mfma_f32_16x16x32_bf16 v[156:159], v[92:95], v[68:71], v[156:159]
    v_mfma_f32_16x16x32_bf16 v[172:175], v[92:95], v[72:75], v[172:175]
    v_mfma_f32_16x16x32_bf16 v[188:191], v[92:95], v[76:79], v[188:191]
    v_add_u32 v11, s41, v9
    s_sub_u32 s40, s40, 1
    s_cmp_lg_u32 s40, 0
    s_cbranch_scc1 k4_kernel_loop
    s_branch k4_kernel_after
k4_kernel_pfat0:
    s_cmp_lg_u32 s32, 3
    s_cbranch_scc1 k4_kernel_pfat0_r
    s_getpc_b64 s[4:5]
k4_kernel_cpf1:
    s_sub_u32 s4, s4, k4_kernel_cpf1-k4_kernel
    s_subb_u32 s5, s5, 0
    s_and_b32 s44, s54, 1
    s_lshl_b32 s44, s44, 13
    v_lshlrev_b32 v6, 7, v2
    v_add_u32 v6, s44, v6
    v_min_u32 v6, k4_kernel_end-k4_kernel-4, v6
    global_load_dword v250, v6, s[4:5]
    s_branch k4_kernel_pfat0_r
k4_kernel_after:
    s_waitcnt lgkmcnt(0)
    s_nop 7
    s_nop 7
    v_and_b32 v3, 15, v2
    v_lshrrev_b32 v4, 4, v2
    s_lshl_b32 s47, s2, 15
    s_add_u32 s44, s47, 0x2000000
    s_cmp_lt_u32 s2, 136
    s_cselect_b32 s47, s47, s44
    s_lshl_b32 s44, s37, 14
    s_add_u32 s47, s47, s44
    v_lshlrev_b32 v6, 4, v2
    s_cmp_eq_u32 s36, s55
    s_cbranch_scc1 k4_kernel_keep
    v_add_u32 v13, s47, v6
    s_mov_b32 s44, 0
    buffer_store_dwordx4 v[128:131], v13, s[24:27], s44 offen sc1
    s_mov_b32 s44, 1024
    buffer_store_dwordx4 v[132:135], v13, s[24:27], s44 offen sc1
    s_mov_b32 s44, 2048
    buffer_store_dwordx4 v[136:139], v13, s[24:27], s44 offen sc1
    s_mov_b32 s44, 3072
    buffer_store_dwordx4 v[140:143], v13, s[24:27], s44 offen sc1
    s_add_u32 s28, s70, 0x1b00000
    s_addc_u32 s29, s71, 0
    s_mov_b32 s30, 0x10000
    s_mov_b32 s31, 0x20000
    s_lshl_b32 s44, s2, 1
    s_add_u32 s44, s44, s37
    s_lshl_b32 s45, s44, 7
    s_xor_b32 s46, s45, 256
    v_mov_b32 v8, s46
    v_mov_b32 v9, 1
    v_mov_b32 v12, s45
    v_cmp_eq_u32 vcc, 0, v2
    v_mov_b32 v10, 0x7ffffff0
    s_nop 0
    v_cndmask_b32 v10, v10, v12, vcc
    s_xor_b32 s47, s47, 0x8000
    v_add_u32 v7, s47, v6
    s_add_u32 s44, s47, 0
    s_lshl_b32 s44, s37, 14
    v_add_u32 v11, s44, v6
    v_add_u32 v11, 131072, v11
    s_mov_b32 s4, 0
    s_barrier
    s_mov_b32 s44, 4096
    buffer_store_dwordx4 v[144:147], v13, s[24:27], s44 offen sc1
    s_mov_b32 s44, 5120
    buffer_store_dwordx4 v[148:151], v13, s[24:27], s44 offen sc1
    s_mov_b32 s44, 6144
    buffer_store_dwordx4 v[152:155], v13, s[24:27], s44 offen sc1
    s_mov_b32 s44, 7168
    buffer_store_dwordx4 v[156:159], v13, s[24:27], s44 offen sc1
    s_barrier
    s_mov_b32 s44, 8192
    buffer_store_dwordx4 v[160:163], v13, s[24:27], s44 offen sc1
    s_mov_b32 s44, 9216
    buffer_store_dwordx4 v[164:167], v13, s[24:27], s44 offen sc1
    s_mov_b32 s44, 10240
    buffer_store_dwordx4 v[168:171], v13, s[24:27], s44 offen sc1
    s_mov_b32 s44, 11264
    buffer_store_dwordx4 v[172:175], v13, s[24:27], s44 offen sc1
    s_barrier
    s_mov_b32 s44, 12288
    buffer_store_dwordx4 v[176:179], v13, s[24:27], s44 offen sc1
    s_mov_b32 s44, 13312
    buffer_store_dwordx4 v[180:183], v13, s[24:27], s44 offen sc1
    s_mov_b32 s44, 14336
    buffer_store_dwordx4 v[184:187], v13, s[24:27], s44 offen sc1
    s_mov_b32 s44, 15360
    buffer_store_dwordx4 v[188:191], v13, s[24:27], s44 offen sc1
    s_barrier
    s_barrier
    s_barrier
    s_barrier
    s_barrier
    s_waitcnt vmcnt(0)
    buffer_store_dwordx2 v[22:23], v10, s[28:31], 0 offen sc1
    buffer_load_dwordx2 v[20:21], v8, s[28:31], 0 offen sc1
    s_barrier
    s_barrier
    s_cmp_lg_u32 s4, 0
    s_cbranch_scc1 k4_kernel_tf9
    s_waitcnt vmcnt(0)
    v_xor_b32 v24, v20, v22
    v_xor_b32 v25, v21, v23
    v_or_b32 v24, v24, v25
    s_nop 0
    v_readfirstlane_b32 s45, v24
    s_nop 3
    s_cmp_eq_u32 s45, 0
    s_cbranch_scc1 k4_kernel_tf9g
    buffer_load_dwordx2 v[20:21], v8, s[28:31], 0 offen sc1
    s_branch k4_kernel_tf9
k4_kernel_tf9g:
    s_mov_b32 s44, 0
    buffer_load_dwordx4 v[32:35], v7, s[24:27], s44 offen sc1
    s_mov_b32 s44, 1024
    buffer_load_dwordx4 v[36:39], v7, s[24:27], s44 offen sc1
    s_mov_b32 s44, 2048
    buffer_load_dwordx4 v[40:43], v7, s[24:27], s44 offen sc1
    s_mov_b32 s44, 3072
    buffer_load_dwordx4 v[44:47], v7, s[24:27], s44 offen sc1
    s_mov_b32 s44, 4096
    buffer_load_dwordx4 v[48:51], v7, s[24:27], s44 offen sc1
    s_mov_b32 s44, 5120
    buffer_load_dwordx4 v[52:55], v7, s[24:27], s44 offen sc1
    s_mov_b32 s44, 6144
    buffer_load_dwordx4 v[56:59], v7, s[24:27], s44 offen sc1
    s_mov_b32 s44, 7168
    buffer_load_dwordx4 v[60:63], v7, s[24:27], s44 offen sc1
    s_mov_b32 s44, 8192
    buffer_load_dwordx4 v[64:67], v7, s[24:27], s44 offen sc1
    s_mov_b32 s44, 9216
    buffer_load_dwordx4 v[68:71], v7, s[24:27], s44 offen sc1
    s_mov_b32 s44, 10240
    buffer_load_dwordx4 v[72:75], v7, s[24:27], s44 offen sc1
    s_mov_b32 s44, 11264
    buffer_load_dwordx4 v[76:79], v7, s[24:27], s44 offen sc1
    s_mov_b32 s44, 12288
    buffer_load_dwordx4 v[80:83], v7, s[24:27], s44 offen sc1
    s_mov_b32 s44, 13312
    buffer_load_dwordx4 v[84:87], v7, s[24:27], s44 offen sc1
    s_mov_b32 s44, 14336
    buffer_load_dwordx4 v[88:91], v7, s[24:27], s44 offen sc1
    s_mov_b32 s44, 15360
    buffer_load_dwordx4 v[92:95], v7, s[24:27], s44 offen sc1
    s_mov_b32 s4, 1
k4_kernel_tf9:
    s_barrier
    s_barrier
k4_kernel_fpoll:
    s_cmp_lg_u32 s4, 0
    s_cbranch_scc1 k4_kernel_tfz
    s_waitcnt vmcnt(0)
    v_xor_b32 v24, v20, v22
    v_xor_b32 v25, v21, v23
    v_or_b32 v24, v24, v25
    s_nop 0
    v_readfirstlane_b32 s45, v24
    s_nop 3
    s_cmp_eq_u32 s45, 0
    s_cbranch_scc1 k4_kernel_tfzg
    buffer_load_dwordx2 v[20:21], v8, s[28:31], 0 offen sc1
    s_branch k4_kernel_tfz
k4_kernel_tfzg:
    s_mov_b32 s44, 0
    buffer_load_dwordx4 v[32:35], v7, s[24:27], s44 offen sc1
    s_mov_b32 s44, 1024
    buffer_load_dwordx4 v[36:39], v7, s[24:27], s44 offen sc1
    s_mov_b32 s44, 2048
    buffer_load_dwordx4 v[40:43], v7, s[24:27], s44 offen sc1
    s_mov_b32 s44, 3072
    buffer_load_dwordx4 v[44:47], v7, s[24:27], s44 offen sc1
    s_mov_b32 s44, 4096
    buffer_load_dwordx4 v[48:51], v7, s[24:27], s44 offen sc1
    s_mov_b32 s44, 5120
    buffer_load_dwordx4 v[52:55], v7, s[24:27], s44 offen sc1
    s_mov_b32 s44, 6144
    buffer_load_dwordx4 v[56:59], v7, s[24:27], s44 offen sc1
    s_mov_b32 s44, 7168
    buffer_load_dwordx4 v[60:63], v7, s[24:27], s44 offen sc1
    s_mov_b32 s44, 8192
    buffer_load_dwordx4 v[64:67], v7, s[24:27], s44 offen sc1
    s_mov_b32 s44, 9216
    buffer_load_dwordx4 v[68:71], v7, s[24:27], s44 offen sc1
    s_mov_b32 s44, 10240
    buffer_load_dwordx4 v[72:75], v7, s[24:27], s44 offen sc1
    s_mov_b32 s44, 11264
    buffer_load_dwordx4 v[76:79], v7, s[24:27], s44 offen sc1
    s_mov_b32 s44, 12288
    buffer_load_dwordx4 v[80:83], v7, s[24:27], s44 offen sc1
    s_mov_b32 s44, 13312
    buffer_load_dwordx4 v[84:87], v7, s[24:27], s44 offen sc1
    s_mov_b32 s44, 14336
    buffer_load_dwordx4 v[88:91], v7, s[24:27], s44 offen sc1
    s_mov_b32 s44, 15360
    buffer_load_dwordx4 v[92:95], v7, s[24:27], s44 offen sc1
    s_mov_b32 s4, 1
k4_kernel_tfz:
    s_cmp_eq_u32 s4, 0
    s_cbranch_scc1 k4_kernel_fpoll
    s_waitcnt vmcnt(15)
    ds_write_b128 v11, v[32:35] offset:0
    s_waitcnt vmcnt(14)
    ds_write_b128 v11, v[36:39] offset:1024
    s_waitcnt vmcnt(13)
    ds_write_b128 v11, v[40:43] offset:2048
    s_waitcnt vmcnt(12)
    ds_write_b128 v11, v[44:47] offset:3072
    s_waitcnt vmcnt(11)
    ds_write_b128 v11, v[48:51] offset:4096
    s_waitcnt vmcnt(10)
    ds_write_b128 v11, v[52:55] offset:5120
    s_waitcnt vmcnt(9)
    ds_write_b128 v11, v[56:59] offset:6144
    s_waitcnt vmcnt(8)
    ds_write_b128 v11, v[60:63] offset:7168
    s_waitcnt vmcnt(7)
    ds_write_b128 v11, v[64:67] offset:8192
    s_waitcnt vmcnt(6)
    ds_write_b128 v11, v[68:71] offset:9216
    s_waitcnt vmcnt(5)
    ds_write_b128 v11, v[72:75] offset:10240
    s_waitcnt vmcnt(4)
    ds_write_b128 v11, v[76:79] offset:11264
    s_waitcnt vmcnt(3)
    ds_write_b128 v11, v[80:83] offset:12288
    s_waitcnt vmcnt(2)
    ds_write_b128 v11, v[84:87] offset:13312
    s_waitcnt vmcnt(1)
    ds_write_b128 v11, v[88:91] offset:14336
    s_waitcnt vmcnt(0)
    ds_write_b128 v11, v[92:95] offset:15360
    s_waitcnt lgkmcnt(0)
    s_barrier
    s_branch k4_kernel_store
k4_kernel_keep:
    s_lshl_b32 s44, s37, 14
    v_add_u32 v11, s44, v6
    v_add_u32 v11, 131072, v11
    s_barrier
    ds_read_b128 v[32:35], v11 offset:0
    ds_read_b128 v[36:39], v11 offset:1024
    ds_read_b128 v[40:43], v11 offset:2048
    ds_read_b128 v[44:47], v11 offset:3072
    ds_read_b128 v[48:51], v11 offset:4096
    ds_read_b128 v[52:55], v11 offset:5120
    ds_read_b128 v[56:59], v11 offset:6144
    ds_read_b128 v[60:63], v11 offset:7168
    ds_read_b128 v[64:67], v11 offset:8192
    ds_read_b128 v[68:71], v11 offset:9216
    ds_read_b128 v[72:75], v11 offset:10240
    ds_read_b128 v[76:79], v11 offset:11264
    ds_read_b128 v[80:83], v11 offset:12288
    ds_read_b128 v[84:87], v11 offset:13312
    ds_read_b128 v[88:91], v11 offset:14336
    ds_read_b128 v[92:95], v11 offset:15360
    s_waitcnt lgkmcnt(12)
    v_pk_add_f32 v[128:129], v[128:129], v[32:33]
    v_pk_add_f32 v[130:131], v[130:131], v[34:35]
    v_pk_add_f32 v[132:133], v[132:133], v[36:37]
    v_pk_add_f32 v[134:135], v[134:135], v[38:39]
    v_pk_add_f32 v[136:137], v[136:137], v[40:41]
    v_pk_add_f32 v[138:139], v[138:139], v[42:43]
    v_pk_add_f32 v[140:141], v[140:141], v[44:45]
    v_pk_add_f32 v[142:143], v[142:143], v[46:47]
    s_waitcnt lgkmcnt(8)
    v_pk_add_f32 v[144:145], v[144:145], v[48:49]
    v_pk_add_f32 v[146:147], v[146:147], v[50:51]
    v_pk_add_f32 v[148:149], v[148:149], v[52:53]
    v_pk_add_f32 v[150:151], v[150:151], v[54:55]
    v_pk_add_f32 v[152:153], v[152:153], v[56:57]
    v_pk_add_f32 v[154:155], v[154:155], v[58:59]
    v_pk_add_f32 v[156:157], v[156:157], v[60:61]
    v_pk_add_f32 v[158:159], v[158:159], v[62:63]
    s_waitcnt lgkmcnt(4)
    v_pk_add_f32 v[160:161], v[160:161], v[64:65]
    v_pk_add_f32 v[162:163], v[162:163], v[66:67]
    v_pk_add_f32 v[164:165], v[164:165], v[68:69]
    v_pk_add_f32 v[166:167], v[166:167], v[70:71]
    v_pk_add_f32 v[168:169], v[168:169], v[72:73]
    v_pk_add_f32 v[170:171], v[170:171], v[74:75]
    v_pk_add_f32 v[172:173], v[172:173], v[76:77]
    v_pk_add_f32 v[174:175], v[174:175], v[78:79]
    s_waitcnt lgkmcnt(0)
    v_pk_add_f32 v[176:177], v[176:177], v[80:81]
    v_pk_add_f32 v[178:179], v[178:179], v[82:83]
    v_pk_add_f32 v[180:181], v[180:181], v[84:85]
    v_pk_add_f32 v[182:183], v[182:183], v[86:87]
    v_pk_add_f32 v[184:185], v[184:185], v[88:89]
    v_pk_add_f32 v[186:187], v[186:187], v[90:91]
    v_pk_add_f32 v[188:189], v[188:189], v[92:93]
    v_pk_add_f32 v[190:191], v[190:191], v[94:95]
    s_lshl_b32 s45, s37, 7
    v_mul_u32_u24 v5, 272, v3
    v_lshl_add_u32 v5, v4, 3, v5
    v_add_u32 v5, s45, v5
    v_cvt_pk_bf16_f32 v128, v128, v129
    v_cvt_pk_bf16_f32 v129, v130, v131
    v_cvt_pk_bf16_f32 v132, v132, v133
    v_cvt_pk_bf16_f32 v133, v134, v135
    v_cvt_pk_bf16_f32 v136, v136, v137
    v_cvt_pk_bf16_f32 v137, v138, v139
    v_cvt_pk_bf16_f32 v140, v140, v141
    v_cvt_pk_bf16_f32 v141, v142, v143
    ds_write_b64 v5, v[128:129] offset:0
    ds_write_b64 v5, v[132:133] offset:32
    ds_write_b64 v5, v[136:137] offset:64
    ds_write_b64 v5, v[140:141] offset:96
    v_cvt_pk_bf16_f32 v144, v144, v145
    v_cvt_pk_bf16_f32 v145, v146, v147
    v_cvt_pk_bf16_f32 v148, v148, v149
    v_cvt_pk_bf16_f32 v149, v150, v151
    v_cvt_pk_bf16_f32 v152, v152, v153
    v_cvt_pk_bf16_f32 v153, v154, v155
    v_cvt_pk_bf16_f32 v156, v156, v157
    v_cvt_pk_bf16_f32 v157, v158, v159
    ds_write_b64 v5, v[144:145] offset:4352
    ds_write_b64 v5, v[148:149] offset:4384
    ds_write_b64 v5, v[152:153] offset:4416
    ds_write_b64 v5, v[156:157] offset:4448
    v_cvt_pk_bf16_f32 v160, v160, v161
    v_cvt_pk_bf16_f32 v161, v162, v163
    v_cvt_pk_bf16_f32 v164, v164, v165
    v_cvt_pk_bf16_f32 v165, v166, v167
    v_cvt_pk_bf16_f32 v168, v168, v169
    v_cvt_pk_bf16_f32 v169, v170, v171
    v_cvt_pk_bf16_f32 v172, v172, v173
    v_cvt_pk_bf16_f32 v173, v174, v175
    ds_write_b64 v5, v[160:161] offset:8704
    ds_write_b64 v5, v[164:165] offset:8736
    ds_write_b64 v5, v[168:169] offset:8768
    ds_write_b64 v5, v[172:173] offset:8800
    v_cvt_pk_bf16_f32 v176, v176, v177
    v_cvt_pk_bf16_f32 v177, v178, v179
    v_cvt_pk_bf16_f32 v180, v180, v181
    v_cvt_pk_bf16_f32 v181, v182, v183
    v_cvt_pk_bf16_f32 v184, v184, v185
    v_cvt_pk_bf16_f32 v185, v186, v187
    v_cvt_pk_bf16_f32 v188, v188, v189
    v_cvt_pk_bf16_f32 v189, v190, v191
    ds_write_b64 v5, v[176:177] offset:13056
    ds_write_b64 v5, v[180:181] offset:13088
    ds_write_b64 v5, v[184:185] offset:13120
    ds_write_b64 v5, v[188:189] offset:13152
    s_waitcnt lgkmcnt(0)
    s_branch k4_kernel_store
k4_kernel_end:
.section .rodata,"a"
.p2align 6
kd_start:
.amdhsa_kernel standalone__mixer_s_mlp__prompt_kernel
  .amdhsa_next_free_vgpr 256
  .amdhsa_next_free_sgpr 102
  .amdhsa_accum_offset 256
  .amdhsa_group_segment_fixed_size 0
  .amdhsa_kernarg_size 64
  .amdhsa_user_sgpr_count 2
  .amdhsa_user_sgpr_kernarg_segment_ptr 1
  .amdhsa_system_sgpr_workgroup_id_x 1
.end_amdhsa_kernel
.p2align 6
```
